```python
import torch

def _softmax(x, axis=-1):
    return torch.softmax(x, dim=axis)

def _gelu(x):
    return torch.nn.functional.gelu(x, approximate='tanh')

def _silu(x):
    return torch.nn.functional.silu(x)

def _sigmoid(x):
    return torch.sigmoid(x)

def _layernorm(x, axis=-1, eps=1e-05):
    m = x.mean(dim=axis, keepdim=True)
    v = x.var(dim=axis, keepdim=True, unbiased=False)
    return (x - m) / torch.sqrt(v + eps)

def _scatter_add(tgt, idx, src, axis=0):
    return tgt.clone().index_add_(axis, idx, src)

def _segment_sum(src, seg, n):
    out = torch.zeros((n,) + src.shape[1:], dtype=src.dtype)
    return out.index_add_(0, seg, src)

def _pad(x, pw):
    flat = tuple((v for pair in reversed(pw) for v in pair))
    return torch.nn.functional.pad(x, flat)
kernel_name = 'adaLN_cond__gqa_block_cached__mixer_token_mlp__decode'

def setup_inputs():

    _w = lambda a: (lambda t: t.to(torch.bfloat16) if t.is_floating_point() else t)(torch.as_tensor(a))

    def _A_setup():
        B, Sq, D = (1, 1, 1024)
        Hq, Hkv, Sk, Dh = (32, 4, 65536, 128)
        assert Hq % Hkv == 0, (Hq, Hkv)
        return {'x': _w((lambda *s: torch.randn(*s, dtype=torch.bfloat16) * 0.1)(B, Sq, D)), 'k_cache': _w((lambda *s: torch.randn(*s, dtype=torch.bfloat16) * 3.2)(B, Hkv, Sk, Dh)), 'v_cache': _w((lambda *s: torch.randn(*s, dtype=torch.bfloat16) * 1.6)(B, Hkv, Sk, Dh)), 'wq': _w((lambda *s: torch.randn(*s, dtype=torch.bfloat16) * 3.2)(D, Hq * Dh) * D ** (-0.5)), 'wo': _w((lambda *s: torch.randn(*s, dtype=torch.bfloat16) * 1.6)(Hq * Dh, D) * (Hq * Dh) ** (-0.5))}
    _A_in = _A_setup()

    def _B_setup():
        B, S, D, F = (1, 1, 1024, 3584)
        return {'x': _w((lambda *s: torch.randn(*s, dtype=torch.bfloat16) * 0.1)(B, S, D)), 'w1': _w((lambda *s: torch.randn(*s, dtype=torch.bfloat16) * 1.6)(S, F) * S ** (-0.5)), 'b1': _w((lambda *s: torch.randn(*s, dtype=torch.bfloat16) * 1.6)(F) * 0.02), 'w2': _w((lambda *s: torch.randn(*s, dtype=torch.bfloat16) * 1.6)(F, S) * F ** (-0.5)), 'b2': _w((lambda *s: torch.randn(*s, dtype=torch.bfloat16) * 1.6)(S) * 0.02)}
    _B_in = _B_setup()
    return {'A_x': _A_in['x'], 'A_k_cache': _A_in['k_cache'], 'A_v_cache': _A_in['v_cache'], 'A_wq': _A_in['wq'], 'A_wo': _A_in['wo'], 'B_x': _B_in['x'], 'B_w1': _B_in['w1'], 'B_b1': _B_in['b1'], 'B_w2': _B_in['w2'], 'B_b2': _B_in['b2'], 'c': _w((lambda *s: torch.randn(*s, dtype=torch.bfloat16) * 0.1)(1, 1024) * 8.0), 'w_mod': _w((lambda *s: torch.randn(*s, dtype=torch.bfloat16) * 0.1)(1024, 6 * 1024) * 1024 ** (-0.5) * 8.0)}

def reference(A_x, A_k_cache, A_v_cache, A_wq, A_wo, B_x, B_w1, B_b1, B_w2, B_b2, c, w_mod):

    def _A_ref(x, k_cache, v_cache, wq, wo):
        B, Sq, D = x.shape
        Hq, Dh = (32, 128)
        Hkv = k_cache.shape[1]
        rep = Hq // Hkv
        q = (lambda x, *d: x.permute(*d))((x @ wq).reshape(B, Sq, Hq, Dh), 0, 2, 1, 3)
        k = (lambda x, n, axis: torch.repeat_interleave(x, n, dim=axis))(k_cache, rep, axis=1)
        v = (lambda x, n, axis: torch.repeat_interleave(x, n, dim=axis))(v_cache, rep, axis=1)
        scores = torch.einsum('bhqd,bhkd->bhqk', q, k) * Dh ** (-0.5)
        p = _softmax(scores, axis=-1)
        o = torch.einsum('bhqk,bhkd->bhqd', p, v)
        return (lambda x, *d: x.permute(*d))(o, 0, 2, 1, 3).reshape(B, Sq, Hq * Dh) @ wo

    def _B_ref(x, w1, b1, w2, b2):
        B, S, D = x.shape
        h = _layernorm(x, axis=-1)
        u = torch.einsum('bsd,sf->bdf', h, w1) + b1
        u = _gelu(u)
        y = torch.einsum('bdf,fs->bds', u, w2) + b2
        return (lambda x, *d: x.permute(*d))(y, 0, 2, 1)
    x = A_x
    mod = (_silu(c) @ w_mod).reshape(c.shape[0], 6, 1, -1)
    sa, ca, ga, sb, cb, gb = (mod[:, 0].clone(), mod[:, 1].clone(), mod[:, 2].clone(), mod[:, 3].clone(), mod[:, 4].clone(), mod[:, 5].clone())
    h = _layernorm(x, axis=-1) * (1 + ca) + sa
    x = x + ga * _A_ref(h, A_k_cache, A_v_cache, A_wq, A_wo)
    h = _layernorm(x, axis=-1) * (1 + cb) + sb
    x = x + gb * _B_ref(h, B_w1, B_b1, B_w2, B_b2)
    return x
```

```asm
; @launch grid=(256,1,1) block=(512,1,1) lds=163840
.amdgcn_target "amdgcn-amd-amdhsa--gfx950"
.text
.globl adaLN_cond__gqa_block_cached__mixer_token_mlp__decode_kernel
.p2align 8
.type adaLN_cond__gqa_block_cached__mixer_token_mlp__decode_kernel,@function
adaLN_cond__gqa_block_cached__mixer_token_mlp__decode_kernel:
  s_cmp_ge_u32 s2, 256
  s_cbranch_scc1 L_end
  s_load_dwordx2 s[24:25], s[0:1], 88
  s_load_dwordx2 s[16:17], s[0:1], 24
  s_load_dwordx16 s[36:51], s[0:1], 0
  s_load_dwordx8 s[52:59], s[0:1], 64
  s_load_dwordx4 s[60:63], s[0:1], 96
  s_load_dwordx2 s[64:65], s[0:1], 112
  v_lshrrev_b32 v1, 6, v0
  s_nop 0
  v_readfirstlane_b32 s3, v1
  v_and_b32 v1, 63, v0
  v_lshrrev_b32 v26, 3, v1
  v_mul_u32_u24 v236, 12288, v26
  v_lshrrev_b32 v26, 4, v1
  v_lshlrev_b32 v26, 1, v26
  v_xor_b32 v26, v26, v1
  v_and_b32 v26, 7, v26
  v_lshl_add_u32 v236, v26, 4, v236
  s_and_b32 s30, s2, 7
  s_lshl_b32 s30, s30, 3
  s_add_u32 s30, s30, s3
  s_mul_i32 s32, s30, 196608
  s_lshr_b32 s30, s2, 3
  s_lshl_b32 s30, s30, 7
  s_add_u32 s32, s32, s30
  s_lshl_b32 s31, s3, 11
  s_add_u32 m0, s31, 131072
  s_mov_b32 s26, 0xc00000
  s_mov_b32 s27, 0x20000
  s_add_u32 s33, s32, 97280
  s_waitcnt lgkmcnt(0)
  buffer_load_dwordx4 v236, s[24:27], s32 offen nt lds
  buffer_load_dwordx4 v236, s[24:27], s33 offen offset:1024 nt lds
  s_mov_b64 s[20:21], s[44:45]
  s_and_b32 s67, s3, 3
  s_mov_b32 s18, 0x800000
  s_mov_b32 s19, 0x20000
  s_cmp_lt_u32 s3, 4
  s_cbranch_scc1 L_A
  s_barrier
  s_branch L_X
L_A:
  s_setprio 1
  s_lshl_b32 s59, s67, 13
  v_lshrrev_b32 v26, 3, v1
  v_mul_u32_u24 v237, 8192, v26
  v_lshrrev_b32 v26, 4, v1
  v_lshlrev_b32 v26, 1, v26
  v_xor_b32 v26, v26, v1
  v_and_b32 v26, 7, v26
  v_lshl_add_u32 v237, v26, 4, v237
  s_and_b32 s30, s2, 3
  s_lshl_b32 s30, s30, 2
  s_add_u32 s30, s30, s67
  s_lshl_b32 s47, s30, 19
  s_lshr_b32 s30, s2, 2
  s_lshl_b32 s30, s30, 7
  s_add_u32 s47, s47, s30
  s_add_u32 s32, s47, 0
  s_add_u32 m0, s59, 98304
  s_nop 0
  buffer_load_dwordx4 v237, s[16:19], s32 offen nt lds
  s_add_u32 s32, s47, 65536
  s_add_u32 m0, s59, 99328
  s_nop 0
  buffer_load_dwordx4 v237, s[16:19], s32 offen nt lds
  s_add_u32 s32, s47, 131072
  s_add_u32 m0, s59, 100352
  s_nop 0
  buffer_load_dwordx4 v237, s[16:19], s32 offen nt lds
  s_add_u32 s32, s47, 196608
  s_add_u32 m0, s59, 101376
  s_nop 0
  buffer_load_dwordx4 v237, s[16:19], s32 offen nt lds
  v_mov_b32 v2, 147456
  v_mov_b32 v3, 1
  s_mov_b32 s6, 0x4000000
  s_mov_b32 s7, 0x20000
  s_mov_b32 s10, 0x4000000
  s_mov_b32 s11, 0x20000
  s_mov_b32 s14, 0x10000000
  s_mov_b32 s15, 0x20000
  s_mov_b32 s22, 0x800000
  s_mov_b32 s23, 0x20000
  s_mov_b64 s[4:5], s[38:39]
  s_mov_b64 s[8:9], s[40:41]
  s_mov_b64 s[12:13], s[64:65]
  s_cmp_lg_u32 s3, 3
  s_cbranch_scc1 L_noinit
  v_lshl_add_u32 v27, v1, 2, v2
  v_mov_b32 v28, 0
  s_mov_b32 exec_lo, 0xffffffff
  s_mov_b32 exec_hi, 0x0
  ds_write_b32 v27, v28 offset:5760
  s_mov_b64 exec, -1
  s_waitcnt lgkmcnt(0)
L_noinit:
  s_barrier
  s_load_dword s66, s[64:65], 12
  v_lshrrev_b32 v24, 4, v1
  v_and_b32 v25, 15, v1
  v_lshlrev_b32 v26, 1, v24
  v_xor_b32 v26, v26, v25
  v_lshlrev_b32 v26, 4, v26
  v_lshl_add_u32 v4, v24, 8, v26
  v_xor_b32 v5, 0x80, v4
  v_xor_b32 v6, 0x10, v4
  v_xor_b32 v7, 0x90, v4
  s_lshl_b32 s68, s2, 18
  s_lshl_b32 s30, s3, 12
  s_add_u32 s68, s68, s30
  s_mul_i32 s38, s3, 24576
  s_waitcnt vmcnt(5)
  s_add_u32 s32, s47, 262144
  s_add_u32 m0, s59, 102400
  s_nop 0
  buffer_load_dwordx4 v237, s[16:19], s32 offen nt lds
  s_waitcnt vmcnt(5)
  s_add_u32 s32, s47, 327680
  s_add_u32 m0, s59, 103424
  s_nop 0
  buffer_load_dwordx4 v237, s[16:19], s32 offen nt lds
  s_mov_b64 exec, 1
  ds_add_u32 v2, v3 offset:5760
  s_mov_b64 exec, -1
  s_waitcnt vmcnt(5)
  s_add_u32 s32, s47, 393216
  s_add_u32 m0, s59, 104448
  s_nop 0
  buffer_load_dwordx4 v237, s[16:19], s32 offen nt lds
  v_and_b32 v26, 7, v25
  v_lshlrev_b32 v26, 1, v26
  v_lshrrev_b32 v27, 3, v25
  v_or_b32 v26, v26, v27
  v_lshrrev_b32 v27, 1, v24
  v_xor_b32 v26, v26, v27
  v_lshlrev_b32 v26, 4, v26
  v_lshl_add_u32 v26, v25, 8, v26
  v_and_b32 v27, 1, v24
  v_lshl_add_u32 v26, v27, 12, v26
  v_add_u32 v8, s38, v26
  v_xor_b32 v9, 0x20, v8
  v_xor_b32 v10, 0x40, v8
  v_xor_b32 v11, 0x60, v8
  v_xor_b32 v12, 0x80, v8
  v_xor_b32 v13, 0xa0, v8
  v_xor_b32 v14, 0xc0, v8
  v_xor_b32 v15, 0xe0, v8
  v_lshrrev_b32 v27, 2, v1
  v_and_b32 v26, 7, v27
  v_lshlrev_b32 v26, 1, v26
  v_lshrrev_b32 v28, 3, v27
  v_or_b32 v26, v26, v28
  v_lshrrev_b32 v28, 1, v1
  v_and_b32 v28, 1, v28
  v_xor_b32 v26, v26, v28
  v_lshlrev_b32 v26, 4, v26
  v_lshl_add_u32 v26, v27, 8, v26
  v_and_b32 v28, 1, v1
  v_lshl_add_u32 v26, v28, 3, v26
  v_add_u32 v16, s38, v26
  v_xor_b32 v17, 0x20, v16
  v_xor_b32 v18, 0x40, v16
  v_xor_b32 v19, 0x60, v16
  v_xor_b32 v20, 0x80, v16
  v_xor_b32 v21, 0xa0, v16
  v_xor_b32 v22, 0xc0, v16
  v_xor_b32 v23, 0xe0, v16
  s_waitcnt vmcnt(5)
  s_add_u32 s32, s47, 458752
  s_add_u32 m0, s59, 105472
  s_nop 0
  buffer_load_dwordx4 v237, s[16:19], s32 offen nt lds
  s_waitcnt vmcnt(5)
  s_add_u32 s39, s68, 0
  s_add_u32 m0, s38, 0
  s_nop 0
  buffer_load_dwordx4 v4, s[4:7], s39 offen offset:0 nt lds
  v_mov_b32 v32, 0
  v_mov_b32 v33, 0
  v_mov_b32 v34, 0
  v_mov_b32 v35, 0
  v_mov_b32 v36, 0
  v_mov_b32 v37, 0
  v_mov_b32 v38, 0
  v_mov_b32 v39, 0
  v_mov_b32 v40, 0
  v_mov_b32 v41, 0
  v_mov_b32 v42, 0
  v_mov_b32 v43, 0
  v_mov_b32 v44, 0
  v_mov_b32 v45, 0
  v_mov_b32 v46, 0
  v_mov_b32 v47, 0
  v_mov_b32 v48, 0
  v_mov_b32 v49, 0
  v_mov_b32 v50, 0
  v_mov_b32 v51, 0
  v_mov_b32 v52, 0
  v_mov_b32 v53, 0
  v_mov_b32 v54, 0
  v_mov_b32 v55, 0
  v_mov_b32 v56, 0
  v_mov_b32 v57, 0
  v_mov_b32 v58, 0
  v_mov_b32 v59, 0
  v_mov_b32 v60, 0
  v_mov_b32 v61, 0
  v_mov_b32 v62, 0
  v_mov_b32 v63, 0
  v_mov_b32 v224, 0xff800000
  v_mov_b32 v225, 0
  s_mov_b32 s40, 0x3db504f3
  s_mov_b32 s41, 0x3fb8aa3b
  s_waitcnt vmcnt(5)
  buffer_load_dwordx4 v5, s[4:7], s39 offen offset:1024 nt lds
  s_waitcnt vmcnt(5)
  buffer_load_dwordx4 v6, s[4:7], s39 offen offset:2048 nt lds
  s_waitcnt vmcnt(5)
  buffer_load_dwordx4 v7, s[4:7], s39 offen offset:3072 nt lds
  s_waitcnt vmcnt(5)
  s_add_u32 s39, s68, 16384
  s_add_u32 m0, s38, 4096
  s_nop 0
  buffer_load_dwordx4 v4, s[4:7], s39 offen offset:0 nt lds
  s_waitcnt vmcnt(5)
  buffer_load_dwordx4 v5, s[4:7], s39 offen offset:1024 nt lds
  s_mov_b64 exec, 1
  ds_add_u32 v2, v3 offset:5764
  s_mov_b64 exec, -1
  s_waitcnt vmcnt(5)
  buffer_load_dwordx4 v6, s[4:7], s39 offen offset:2048 nt lds
  v_lshrrev_b32 v26, 2, v1
  v_lshlrev_b32 v28, 7, v26
  v_and_b32 v26, 6, v26
  v_lshrrev_b32 v27, 1, v1
  v_and_b32 v27, 1, v27
  v_lshl_add_u32 v27, s67, 1, v27
  v_xor_b32 v26, v26, v27
  v_lshl_add_u32 v28, v26, 4, v28
  v_and_b32 v26, 1, v1
  v_lshl_add_u32 v28, v26, 3, v28
  v_add_u32 v28, 0, v28
  s_lshr_b32 s42, s2, 6
  v_lshrrev_b32 v26, 5, v1
  v_lshlrev_b32 v27, 1, v26
  v_xor_b32 v27, v27, v1
  v_and_b32 v27, 31, v27
  v_lshlrev_b32 v27, 4, v27
  v_lshl_add_u32 v238, v26, 11, v27
  v_xor_b32 v239, 0x40, v238
  v_xor_b32 v240, 0x80, v238
  v_xor_b32 v241, 0xc0, v238
  v_add_u32 v29, 49152, v28
  v_lshl_add_u32 v30, v24, 3, v2
  v_lshl_add_u32 v30, s42, 9, v30
  v_lshlrev_b32 v242, 4, v24
  v_and_b32 v26, 7, v1
  v_mul_u32_u24 v26, 528, v26
  v_lshl_add_u32 v26, v24, 4, v26
  v_add_u32 v31, s38, v26
  s_waitcnt lgkmcnt(0)
  s_add_u32 s66, s66, 1
  s_and_b32 s86, s66, 0xff
  s_xor_b32 s62, s86, 0x5a
  s_lshl_b32 s87, s86, 8
  s_or_b32 s87, s87, s62
  s_mul_i32 s88, s86, 0x1010101
  s_and_b32 s63, s88, 0x3030303
  s_add_u32 s63, s63, 0x30201
  s_xor_b32 s88, s88, 0x5a0000
  s_mov_b32 s89, 0x0c0c0400
  s_mov_b32 s90, 0x04000c0c
  v_mov_b32 v247, 0xffffff00
  s_and_b32 s91, s2, 0xf8
  v_add_u32 v243, 1, v24
  v_and_b32 v243, 3, v243
  v_xor_b32 v243, s86, v243
  s_waitcnt vmcnt(5)
  buffer_load_dwordx4 v7, s[4:7], s39 offen offset:3072 nt lds
  s_waitcnt vmcnt(5)
  s_add_u32 s39, s68, 32768
  s_add_u32 m0, s38, 8192
  s_nop 0
  buffer_load_dwordx4 v4, s[4:7], s39 offen offset:0 nt lds
  s_waitcnt vmcnt(5)
  buffer_load_dwordx4 v5, s[4:7], s39 offen offset:1024 nt lds
  s_waitcnt vmcnt(5)
  buffer_load_dwordx4 v6, s[4:7], s39 offen offset:2048 nt lds
  s_waitcnt vmcnt(5)
  buffer_load_dwordx4 v7, s[4:7], s39 offen offset:3072 nt lds
  s_waitcnt vmcnt(5)
  s_add_u32 s39, s68, 49152
  s_add_u32 m0, s38, 12288
  s_nop 0
  buffer_load_dwordx4 v4, s[4:7], s39 offen offset:0 nt lds
  s_waitcnt vmcnt(5)
  buffer_load_dwordx4 v5, s[4:7], s39 offen offset:1024 nt lds
  ds_read_b128 v[96:99], v8 offset:0
  ds_read_b128 v[100:103], v9 offset:0
  ds_read_b128 v[104:107], v10 offset:0
  ds_read_b128 v[108:111], v11 offset:0
  ds_read_b128 v[112:115], v12 offset:0
  ds_read_b128 v[116:119], v13 offset:0
  ds_read_b128 v[120:123], v14 offset:0
  ds_read_b128 v[124:127], v15 offset:0
  s_waitcnt lgkmcnt(0)
  s_waitcnt vmcnt(5)
  buffer_load_dwordx4 v6, s[4:7], s39 offen offset:2048 nt lds
  s_waitcnt vmcnt(5)
  buffer_load_dwordx4 v7, s[4:7], s39 offen offset:3072 nt lds
  s_waitcnt vmcnt(5)
  s_add_u32 s39, s68, 65536
  s_add_u32 m0, s38, 16384
  s_nop 0
  buffer_load_dwordx4 v4, s[4:7], s39 offen offset:0 nt lds
  s_waitcnt vmcnt(5)
  buffer_load_dwordx4 v5, s[4:7], s39 offen offset:1024 nt lds
  s_waitcnt vmcnt(5)
  buffer_load_dwordx4 v6, s[4:7], s39 offen offset:2048 nt lds
  s_waitcnt vmcnt(5)
  buffer_load_dwordx4 v7, s[4:7], s39 offen offset:3072 nt lds
  s_waitcnt vmcnt(5)
  s_add_u32 s39, s68, 81920
  s_add_u32 m0, s38, 20480
  s_nop 0
  buffer_load_dwordx4 v4, s[4:7], s39 offen offset:0 nt lds
  s_mov_b64 exec, 1
  ds_add_u32 v2, v3 offset:5800
  s_mov_b64 exec, -1
  s_waitcnt vmcnt(5)
  buffer_load_dwordx4 v5, s[4:7], s39 offen offset:1024 nt lds
  ds_read_b128 v[128:131], v8 offset:8192
  ds_read_b128 v[132:135], v9 offset:8192
  ds_read_b128 v[136:139], v10 offset:8192
  ds_read_b128 v[140:143], v11 offset:8192
  ds_read_b128 v[144:147], v12 offset:8192
  ds_read_b128 v[148:151], v13 offset:8192
  ds_read_b128 v[152:155], v14 offset:8192
  ds_read_b128 v[156:159], v15 offset:8192
  s_waitcnt lgkmcnt(0)
  s_waitcnt vmcnt(5)
  buffer_load_dwordx4 v6, s[4:7], s39 offen offset:2048 nt lds
  s_waitcnt vmcnt(5)
  buffer_load_dwordx4 v7, s[4:7], s39 offen offset:3072 nt lds
  s_waitcnt vmcnt(5)
  s_add_u32 s39, s68, 98304
  s_add_u32 m0, s38, 0
  s_nop 0
  buffer_load_dwordx4 v4, s[4:7], s39 offen offset:0 nt lds
  s_waitcnt vmcnt(5)
  buffer_load_dwordx4 v5, s[4:7], s39 offen offset:1024 nt lds
  s_waitcnt vmcnt(5)
  buffer_load_dwordx4 v6, s[4:7], s39 offen offset:2048 nt lds
  s_waitcnt vmcnt(5)
  buffer_load_dwordx4 v7, s[4:7], s39 offen offset:3072 nt lds
  s_waitcnt vmcnt(5)
  s_add_u32 s39, s68, 114688
  s_add_u32 m0, s38, 4096
  s_nop 0
  buffer_load_dwordx4 v4, s[4:7], s39 offen offset:0 nt lds
  s_waitcnt vmcnt(5)
  buffer_load_dwordx4 v5, s[4:7], s39 offen offset:1024 nt lds
  ds_read_b128 v[160:163], v8 offset:16384
  ds_read_b128 v[164:167], v9 offset:16384
  ds_read_b128 v[168:171], v10 offset:16384
  ds_read_b128 v[172:175], v11 offset:16384
  ds_read_b128 v[176:179], v12 offset:16384
  ds_read_b128 v[180:183], v13 offset:16384
  ds_read_b128 v[184:187], v14 offset:16384
  ds_read_b128 v[188:191], v15 offset:16384
  s_waitcnt lgkmcnt(0)
  s_waitcnt vmcnt(5)
  buffer_load_dwordx4 v6, s[4:7], s39 offen offset:2048 nt lds
  s_waitcnt vmcnt(5)
  buffer_load_dwordx4 v7, s[4:7], s39 offen offset:3072 nt lds
  s_waitcnt vmcnt(5)
  s_add_u32 s39, s68, 131072
  s_add_u32 m0, s38, 8192
  s_nop 0
  buffer_load_dwordx4 v4, s[4:7], s39 offen offset:0 nt lds
  s_waitcnt vmcnt(5)
  buffer_load_dwordx4 v5, s[4:7], s39 offen offset:1024 nt lds
  s_waitcnt vmcnt(5)
  buffer_load_dwordx4 v6, s[4:7], s39 offen offset:2048 nt lds
  s_waitcnt vmcnt(5)
  buffer_load_dwordx4 v7, s[4:7], s39 offen offset:3072 nt lds
  s_waitcnt vmcnt(5)
  s_add_u32 s39, s68, 147456
  s_add_u32 m0, s38, 12288
  s_nop 0
  buffer_load_dwordx4 v4, s[4:7], s39 offen offset:0 nt lds
  s_waitcnt vmcnt(5)
  buffer_load_dwordx4 v5, s[4:7], s39 offen offset:1024 nt lds
  ds_read_b128 v[192:195], v8 offset:0
  ds_read_b128 v[196:199], v9 offset:0
  ds_read_b128 v[200:203], v10 offset:0
  ds_read_b128 v[204:207], v11 offset:0
  ds_read_b128 v[208:211], v12 offset:0
  ds_read_b128 v[212:215], v13 offset:0
  ds_read_b128 v[216:219], v14 offset:0
  ds_read_b128 v[220:223], v15 offset:0
  s_waitcnt lgkmcnt(0)
  s_waitcnt vmcnt(5)
  buffer_load_dwordx4 v6, s[4:7], s39 offen offset:2048 nt lds
  s_waitcnt vmcnt(5)
  buffer_load_dwordx4 v7, s[4:7], s39 offen offset:3072 nt lds
  s_waitcnt vmcnt(5)
  s_add_u32 s39, s68, 163840
  s_add_u32 m0, s38, 16384
  s_nop 0
  buffer_load_dwordx4 v4, s[4:7], s39 offen offset:0 nt lds
  s_waitcnt vmcnt(5)
  buffer_load_dwordx4 v5, s[4:7], s39 offen offset:1024 nt lds
  s_waitcnt vmcnt(5)
  buffer_load_dwordx4 v6, s[4:7], s39 offen offset:2048 nt lds
  s_waitcnt vmcnt(5)
  buffer_load_dwordx4 v7, s[4:7], s39 offen offset:3072 nt lds
  s_waitcnt vmcnt(5)
  s_add_u32 s39, s68, 180224
  s_add_u32 m0, s38, 20480
  s_nop 0
  buffer_load_dwordx4 v4, s[4:7], s39 offen offset:0 nt lds
  s_waitcnt vmcnt(5)
  buffer_load_dwordx4 v5, s[4:7], s39 offen offset:1024 nt lds
  s_waitcnt vmcnt(5)
  buffer_load_dwordx4 v6, s[4:7], s39 offen offset:2048 nt lds
  s_mov_b64 exec, 1
  ds_add_u32 v2, v3 offset:5804
  s_mov_b64 exec, -1
  s_waitcnt vmcnt(5)
  buffer_load_dwordx4 v7, s[4:7], s39 offen offset:3072 nt lds
  s_waitcnt vmcnt(5)
  s_add_u32 s39, s68, 196608
  s_add_u32 m0, s38, 0
  s_nop 0
  buffer_load_dwordx4 v4, s[4:7], s39 offen offset:0 nt lds
  s_waitcnt vmcnt(5)
  buffer_load_dwordx4 v5, s[4:7], s39 offen offset:1024 nt lds
  s_waitcnt vmcnt(5)
  buffer_load_dwordx4 v6, s[4:7], s39 offen offset:2048 nt lds
  s_waitcnt vmcnt(5)
  buffer_load_dwordx4 v7, s[4:7], s39 offen offset:3072 nt lds
  s_waitcnt vmcnt(5)
  s_add_u32 s39, s68, 212992
  s_add_u32 m0, s38, 4096
  s_nop 0
  buffer_load_dwordx4 v4, s[4:7], s39 offen offset:0 nt lds
  s_waitcnt vmcnt(5)
  buffer_load_dwordx4 v5, s[4:7], s39 offen offset:1024 nt lds
  s_waitcnt vmcnt(5)
  buffer_load_dwordx4 v6, s[4:7], s39 offen offset:2048 nt lds
  s_waitcnt vmcnt(5)
  buffer_load_dwordx4 v7, s[4:7], s39 offen offset:3072 nt lds
  s_mov_b32 s69, 524288
W_1:
  ds_read_b32 v26, v2 offset:5860
  s_waitcnt lgkmcnt(0)
  v_readfirstlane_b32 s30, v26
  s_nop 0
  s_cmp_ge_u32 s30, 4
  s_cbranch_scc1 WD_2
  s_sleep 1
  s_sub_u32 s69, s69, 1
  s_cbranch_scc0 W_1
WD_2:
  s_waitcnt vmcnt(5)
  s_add_u32 s39, s68, 229376
  s_add_u32 m0, s59, 98304
  s_nop 0
  buffer_load_dwordx4 v4, s[4:7], s39 offen offset:0 nt lds
  s_waitcnt vmcnt(5)
  buffer_load_dwordx4 v5, s[4:7], s39 offen offset:1024 nt lds
  s_waitcnt vmcnt(5)
  buffer_load_dwordx4 v6, s[4:7], s39 offen offset:2048 nt lds
  s_waitcnt vmcnt(5)
  buffer_load_dwordx4 v7, s[4:7], s39 offen offset:3072 nt lds
  s_waitcnt vmcnt(5)
  s_add_u32 s39, s68, 245760
  s_add_u32 m0, s59, 102400
  s_nop 0
  buffer_load_dwordx4 v4, s[4:7], s39 offen offset:0 nt lds
  s_mov_b32 s69, 524288
W_3:
  ds_read_b32 v26, v2 offset:5772
  s_waitcnt lgkmcnt(0)
  v_readfirstlane_b32 s30, v26
  s_nop 0
  s_cmp_ge_u32 s30, 4
  s_cbranch_scc1 WD_4
  s_sleep 1
  s_sub_u32 s69, s69, 1
  s_cbranch_scc0 W_3
WD_4:
  v_and_b32 v26, 7, v1
  v_mul_u32_u24 v26, 272, v26
  v_lshrrev_b32 v27, 5, v1
  v_lshl_add_u32 v26, v27, 4, v26
  v_add_u32 v26, 149504, v26
  s_mov_b32 exec_lo, 0xff0000ff
  s_mov_b32 exec_hi, 0xff0000ff
  ds_read_b128 v[32:35], v26 offset:0
  ds_read_b128 v[36:39], v26 offset:32
  ds_read_b128 v[40:43], v26 offset:64
  ds_read_b128 v[44:47], v26 offset:96
  ds_read_b128 v[48:51], v26 offset:128
  ds_read_b128 v[52:55], v26 offset:160
  ds_read_b128 v[56:59], v26 offset:192
  ds_read_b128 v[60:63], v26 offset:224
  s_mov_b64 exec, -1
  s_waitcnt lgkmcnt(0)
  s_waitcnt vmcnt(5)
  buffer_load_dwordx4 v5, s[4:7], s39 offen offset:1024 nt lds
  v_mfma_f32_16x16x32_bf16 v[64:67], v[96:99], v[32:35], 0
  v_mfma_f32_16x16x32_bf16 v[64:67], v[100:103], v[36:39], v[64:67]
  v_mfma_f32_16x16x32_bf16 v[64:67], v[104:107], v[40:43], v[64:67]
  v_mfma_f32_16x16x32_bf16 v[64:67], v[108:111], v[44:47], v[64:67]
  v_mfma_f32_16x16x32_bf16 v[64:67], v[112:115], v[48:51], v[64:67]
  v_mfma_f32_16x16x32_bf16 v[64:67], v[116:119], v[52:55], v[64:67]
  v_mfma_f32_16x16x32_bf16 v[64:67], v[120:123], v[56:59], v[64:67]
  v_mfma_f32_16x16x32_bf16 v[64:67], v[124:127], v[60:63], v[64:67]
  s_waitcnt vmcnt(5)
  buffer_load_dwordx4 v6, s[4:7], s39 offen offset:2048 nt lds
  s_nop 5
  v_cvt_pk_bf16_f32 v64, 0, v64
  v_cvt_pk_bf16_f32 v65, 0, v65
  v_cvt_pk_bf16_f32 v66, 0, v66
  v_cvt_pk_bf16_f32 v67, 0, v67
  v_mul_f32 v64, s40, v64
  v_mul_f32 v65, s40, v65
  v_mul_f32 v66, s40, v66
  v_mul_f32 v67, s40, v67
  v_cvt_pk_bf16_f32 v64, 0, v64
  v_cvt_pk_bf16_f32 v65, 0, v65
  v_cvt_pk_bf16_f32 v66, 0, v66
  v_cvt_pk_bf16_f32 v67, 0, v67
  v_max3_f32 v224, v224, v64, v65
  v_max3_f32 v224, v224, v66, v67
  v_mfma_f32_16x16x32_bf16 v[68:71], v[128:131], v[32:35], 0
  v_mfma_f32_16x16x32_bf16 v[68:71], v[132:135], v[36:39], v[68:71]
  v_mfma_f32_16x16x32_bf16 v[68:71], v[136:139], v[40:43], v[68:71]
  v_mfma_f32_16x16x32_bf16 v[68:71], v[140:143], v[44:47], v[68:71]
  v_mfma_f32_16x16x32_bf16 v[68:71], v[144:147], v[48:51], v[68:71]
  v_mfma_f32_16x16x32_bf16 v[68:71], v[148:151], v[52:55], v[68:71]
  v_mfma_f32_16x16x32_bf16 v[68:71], v[152:155], v[56:59], v[68:71]
  v_mfma_f32_16x16x32_bf16 v[68:71], v[156:159], v[60:63], v[68:71]
  ds_read_b128 v[96:99], v8 offset:8192
  ds_read_b128 v[100:103], v9 offset:8192
  ds_read_b128 v[104:107], v10 offset:8192
  ds_read_b128 v[108:111], v11 offset:8192
  ds_read_b128 v[112:115], v12 offset:8192
  ds_read_b128 v[116:119], v13 offset:8192
  ds_read_b128 v[120:123], v14 offset:8192
  ds_read_b128 v[124:127], v15 offset:8192
  s_waitcnt lgkmcnt(0)
  s_waitcnt vmcnt(5)
  buffer_load_dwordx4 v7, s[4:7], s39 offen offset:3072 nt lds
  v_cvt_pk_bf16_f32 v68, 0, v68
  v_cvt_pk_bf16_f32 v69, 0, v69
  v_cvt_pk_bf16_f32 v70, 0, v70
  v_cvt_pk_bf16_f32 v71, 0, v71
  v_mul_f32 v68, s40, v68
  v_mul_f32 v69, s40, v69
  v_mul_f32 v70, s40, v70
  v_mul_f32 v71, s40, v71
  v_cvt_pk_bf16_f32 v68, 0, v68
  v_cvt_pk_bf16_f32 v69, 0, v69
  v_cvt_pk_bf16_f32 v70, 0, v70
  v_cvt_pk_bf16_f32 v71, 0, v71
  v_max3_f32 v224, v224, v68, v69
  v_max3_f32 v224, v224, v70, v71
  v_mfma_f32_16x16x32_bf16 v[72:75], v[160:163], v[32:35], 0
  v_mfma_f32_16x16x32_bf16 v[72:75], v[164:167], v[36:39], v[72:75]
  v_mfma_f32_16x16x32_bf16 v[72:75], v[168:171], v[40:43], v[72:75]
  v_mfma_f32_16x16x32_bf16 v[72:75], v[172:175], v[44:47], v[72:75]
  v_mfma_f32_16x16x32_bf16 v[72:75], v[176:179], v[48:51], v[72:75]
  v_mfma_f32_16x16x32_bf16 v[72:75], v[180:183], v[52:55], v[72:75]
  v_mfma_f32_16x16x32_bf16 v[72:75], v[184:187], v[56:59], v[72:75]
  v_mfma_f32_16x16x32_bf16 v[72:75], v[188:191], v[60:63], v[72:75]
  ds_read_b128 v[128:131], v8 offset:16384
  ds_read_b128 v[132:135], v9 offset:16384
  ds_read_b128 v[136:139], v10 offset:16384
  ds_read_b128 v[140:143], v11 offset:16384
  ds_read_b128 v[144:147], v12 offset:16384
  ds_read_b128 v[148:151], v13 offset:16384
  ds_read_b128 v[152:155], v14 offset:16384
  ds_read_b128 v[156:159], v15 offset:16384
  s_waitcnt lgkmcnt(0)
  s_waitcnt vmcnt(5)
  s_add_u32 s39, s68, 0
  s_add_u32 m0, s38, 8192
  s_nop 0
  buffer_load_dwordx4 v4, s[8:11], s39 offen offset:0 nt lds
  v_cvt_pk_bf16_f32 v72, 0, v72
  v_cvt_pk_bf16_f32 v73, 0, v73
  v_cvt_pk_bf16_f32 v74, 0, v74
  v_cvt_pk_bf16_f32 v75, 0, v75
  v_mul_f32 v72, s40, v72
  v_mul_f32 v73, s40, v73
  v_mul_f32 v74, s40, v74
  v_mul_f32 v75, s40, v75
  v_cvt_pk_bf16_f32 v72, 0, v72
  v_cvt_pk_bf16_f32 v73, 0, v73
  v_cvt_pk_bf16_f32 v74, 0, v74
  v_cvt_pk_bf16_f32 v75, 0, v75
  v_max3_f32 v224, v224, v72, v73
  v_max3_f32 v224, v224, v74, v75
  v_mfma_f32_16x16x32_bf16 v[76:79], v[192:195], v[32:35], 0
  v_mfma_f32_16x16x32_bf16 v[76:79], v[196:199], v[36:39], v[76:79]
  v_mfma_f32_16x16x32_bf16 v[76:79], v[200:203], v[40:43], v[76:79]
  v_mfma_f32_16x16x32_bf16 v[76:79], v[204:207], v[44:47], v[76:79]
  v_mfma_f32_16x16x32_bf16 v[76:79], v[208:211], v[48:51], v[76:79]
  v_mfma_f32_16x16x32_bf16 v[76:79], v[212:215], v[52:55], v[76:79]
  v_mfma_f32_16x16x32_bf16 v[76:79], v[216:219], v[56:59], v[76:79]
  v_mfma_f32_16x16x32_bf16 v[76:79], v[220:223], v[60:63], v[76:79]
  ds_read_b128 v[160:163], v8 offset:0
  ds_read_b128 v[164:167], v9 offset:0
  ds_read_b128 v[168:171], v10 offset:0
  ds_read_b128 v[172:175], v11 offset:0
  ds_read_b128 v[176:179], v12 offset:0
  ds_read_b128 v[180:183], v13 offset:0
  ds_read_b128 v[184:187], v14 offset:0
  ds_read_b128 v[188:191], v15 offset:0
  s_waitcnt lgkmcnt(0)
  s_waitcnt vmcnt(5)
  buffer_load_dwordx4 v5, s[8:11], s39 offen offset:1024 nt lds
  v_cvt_pk_bf16_f32 v76, 0, v76
  v_cvt_pk_bf16_f32 v77, 0, v77
  v_cvt_pk_bf16_f32 v78, 0, v78
  v_cvt_pk_bf16_f32 v79, 0, v79
  v_mul_f32 v76, s40, v76
  v_mul_f32 v77, s40, v77
  v_mul_f32 v78, s40, v78
  v_mul_f32 v79, s40, v79
  v_cvt_pk_bf16_f32 v76, 0, v76
  v_cvt_pk_bf16_f32 v77, 0, v77
  v_cvt_pk_bf16_f32 v78, 0, v78
  v_cvt_pk_bf16_f32 v79, 0, v79
  v_max3_f32 v224, v224, v76, v77
  v_max3_f32 v224, v224, v78, v79
  v_mfma_f32_16x16x32_bf16 v[80:83], v[96:99], v[32:35], 0
  v_mfma_f32_16x16x32_bf16 v[80:83], v[100:103], v[36:39], v[80:83]
  v_mfma_f32_16x16x32_bf16 v[80:83], v[104:107], v[40:43], v[80:83]
  v_mfma_f32_16x16x32_bf16 v[80:83], v[108:111], v[44:47], v[80:83]
  v_mfma_f32_16x16x32_bf16 v[80:83], v[112:115], v[48:51], v[80:83]
  v_mfma_f32_16x16x32_bf16 v[80:83], v[116:119], v[52:55], v[80:83]
  v_mfma_f32_16x16x32_bf16 v[80:83], v[120:123], v[56:59], v[80:83]
  v_mfma_f32_16x16x32_bf16 v[80:83], v[124:127], v[60:63], v[80:83]
  s_waitcnt vmcnt(5)
  buffer_load_dwordx4 v6, s[8:11], s39 offen offset:2048 nt lds
  s_nop 5
  v_cvt_pk_bf16_f32 v80, 0, v80
  v_cvt_pk_bf16_f32 v81, 0, v81
  v_cvt_pk_bf16_f32 v82, 0, v82
  v_cvt_pk_bf16_f32 v83, 0, v83
  v_mul_f32 v80, s40, v80
  v_mul_f32 v81, s40, v81
  v_mul_f32 v82, s40, v82
  v_mul_f32 v83, s40, v83
  v_cvt_pk_bf16_f32 v80, 0, v80
  v_cvt_pk_bf16_f32 v81, 0, v81
  v_cvt_pk_bf16_f32 v82, 0, v82
  v_cvt_pk_bf16_f32 v83, 0, v83
  v_max3_f32 v224, v224, v80, v81
  v_max3_f32 v224, v224, v82, v83
  v_mfma_f32_16x16x32_bf16 v[84:87], v[128:131], v[32:35], 0
  v_mfma_f32_16x16x32_bf16 v[84:87], v[132:135], v[36:39], v[84:87]
  v_mfma_f32_16x16x32_bf16 v[84:87], v[136:139], v[40:43], v[84:87]
  v_mfma_f32_16x16x32_bf16 v[84:87], v[140:143], v[44:47], v[84:87]
  v_mfma_f32_16x16x32_bf16 v[84:87], v[144:147], v[48:51], v[84:87]
  v_mfma_f32_16x16x32_bf16 v[84:87], v[148:151], v[52:55], v[84:87]
  v_mfma_f32_16x16x32_bf16 v[84:87], v[152:155], v[56:59], v[84:87]
  v_mfma_f32_16x16x32_bf16 v[84:87], v[156:159], v[60:63], v[84:87]
  s_waitcnt vmcnt(5)
  buffer_load_dwordx4 v7, s[8:11], s39 offen offset:3072 nt lds
  s_nop 5
  v_cvt_pk_bf16_f32 v84, 0, v84
  v_cvt_pk_bf16_f32 v85, 0, v85
  v_cvt_pk_bf16_f32 v86, 0, v86
  v_cvt_pk_bf16_f32 v87, 0, v87
  v_mul_f32 v84, s40, v84
  v_mul_f32 v85, s40, v85
  v_mul_f32 v86, s40, v86
  v_mul_f32 v87, s40, v87
  v_cvt_pk_bf16_f32 v84, 0, v84
  v_cvt_pk_bf16_f32 v85, 0, v85
  v_cvt_pk_bf16_f32 v86, 0, v86
  v_cvt_pk_bf16_f32 v87, 0, v87
  v_max3_f32 v224, v224, v84, v85
  v_max3_f32 v224, v224, v86, v87
  v_mfma_f32_16x16x32_bf16 v[88:91], v[160:163], v[32:35], 0
  v_mfma_f32_16x16x32_bf16 v[88:91], v[164:167], v[36:39], v[88:91]
  v_mfma_f32_16x16x32_bf16 v[88:91], v[168:171], v[40:43], v[88:91]
  v_mfma_f32_16x16x32_bf16 v[88:91], v[172:175], v[44:47], v[88:91]
  v_mfma_f32_16x16x32_bf16 v[88:91], v[176:179], v[48:51], v[88:91]
  v_mfma_f32_16x16x32_bf16 v[88:91], v[180:183], v[52:55], v[88:91]
  v_mfma_f32_16x16x32_bf16 v[88:91], v[184:187], v[56:59], v[88:91]
  v_mfma_f32_16x16x32_bf16 v[88:91], v[188:191], v[60:63], v[88:91]
  s_waitcnt vmcnt(5)
  s_add_u32 s39, s68, 32768
  s_add_u32 m0, s38, 12288
  s_nop 0
  buffer_load_dwordx4 v4, s[8:11], s39 offen offset:0 nt lds
  s_nop 2
  v_cvt_pk_bf16_f32 v88, 0, v88
  v_cvt_pk_bf16_f32 v89, 0, v89
  v_cvt_pk_bf16_f32 v90, 0, v90
  v_cvt_pk_bf16_f32 v91, 0, v91
  v_mul_f32 v88, s40, v88
  v_mul_f32 v89, s40, v89
  v_mul_f32 v90, s40, v90
  v_mul_f32 v91, s40, v91
  v_cvt_pk_bf16_f32 v88, 0, v88
  v_cvt_pk_bf16_f32 v89, 0, v89
  v_cvt_pk_bf16_f32 v90, 0, v90
  v_cvt_pk_bf16_f32 v91, 0, v91
  v_max3_f32 v224, v224, v88, v89
  v_max3_f32 v224, v224, v90, v91
  s_waitcnt vmcnt(5)
  buffer_load_dwordx4 v5, s[8:11], s39 offen offset:1024 nt lds
  s_sub_u32 s30, s59, s38
  s_add_u32 s30, s30, 98304
  v_add_u32 v8, s30, v8
  v_add_u32 v9, s30, v9
  v_add_u32 v10, s30, v10
  v_add_u32 v11, s30, v11
  v_add_u32 v12, s30, v12
  v_add_u32 v13, s30, v13
  v_add_u32 v14, s30, v14
  v_add_u32 v15, s30, v15
  ds_read_b128 v[192:195], v8 offset:0
  ds_read_b128 v[196:199], v9 offset:0
  ds_read_b128 v[200:203], v10 offset:0
  ds_read_b128 v[204:207], v11 offset:0
  ds_read_b128 v[208:211], v12 offset:0
  ds_read_b128 v[212:215], v13 offset:0
  ds_read_b128 v[216:219], v14 offset:0
  ds_read_b128 v[220:223], v15 offset:0
  s_waitcnt lgkmcnt(0)
  s_waitcnt vmcnt(5)
  buffer_load_dwordx4 v6, s[8:11], s39 offen offset:2048 nt lds
  v_mfma_f32_16x16x32_bf16 v[92:95], v[192:195], v[32:35], 0
  v_mfma_f32_16x16x32_bf16 v[92:95], v[196:199], v[36:39], v[92:95]
  v_mfma_f32_16x16x32_bf16 v[92:95], v[200:203], v[40:43], v[92:95]
  v_mfma_f32_16x16x32_bf16 v[92:95], v[204:207], v[44:47], v[92:95]
  v_mfma_f32_16x16x32_bf16 v[92:95], v[208:211], v[48:51], v[92:95]
  v_mfma_f32_16x16x32_bf16 v[92:95], v[212:215], v[52:55], v[92:95]
  v_mfma_f32_16x16x32_bf16 v[92:95], v[216:219], v[56:59], v[92:95]
  v_mfma_f32_16x16x32_bf16 v[92:95], v[220:223], v[60:63], v[92:95]
  s_waitcnt vmcnt(5)
  buffer_load_dwordx4 v7, s[8:11], s39 offen offset:3072 nt lds
  s_nop 5
  v_cvt_pk_bf16_f32 v92, 0, v92
  v_cvt_pk_bf16_f32 v93, 0, v93
  v_cvt_pk_bf16_f32 v94, 0, v94
  v_cvt_pk_bf16_f32 v95, 0, v95
  v_mul_f32 v92, s40, v92
  v_mul_f32 v93, s40, v93
  v_mul_f32 v94, s40, v94
  v_mul_f32 v95, s40, v95
  v_cvt_pk_bf16_f32 v92, 0, v92
  v_cvt_pk_bf16_f32 v93, 0, v93
  v_cvt_pk_bf16_f32 v94, 0, v94
  v_cvt_pk_bf16_f32 v95, 0, v95
  v_max3_f32 v224, v224, v92, v93
  v_max3_f32 v224, v224, v94, v95
  s_waitcnt vmcnt(5)
  s_add_u32 s39, s68, 16384
  s_add_u32 m0, s38, 0
  s_nop 0
  buffer_load_dwordx4 v4, s[8:11], s39 offen offset:0 nt lds
  v_max_f32_dpp v224, v224, v224 row_ror:8 row_mask:0xf bank_mask:0xf
  v_mov_b32 v26, v224
  s_nop 1
  v_permlane16_swap_b32 v224, v26
  v_max_f32 v224, v224, v26
  v_mov_b32 v26, v224
  s_nop 1
  v_permlane32_swap_b32 v224, v26
  v_max_f32 v224, v224, v26
  v_mul_f32 v224, s41, v224
  s_waitcnt vmcnt(5)
  buffer_load_dwordx4 v5, s[8:11], s39 offen offset:1024 nt lds
  v_fma_f32 v64, v64, s41, -v224
  v_fma_f32 v65, v65, s41, -v224
  v_fma_f32 v66, v66, s41, -v224
  v_fma_f32 v67, v67, s41, -v224
  v_exp_f32 v64, v64
  v_exp_f32 v65, v65
  v_exp_f32 v66, v66
  v_exp_f32 v67, v67
  v_cvt_pk_bf16_f32 v32, v64, v65
  v_cvt_pk_bf16_f32 v33, v66, v67
  v_add_f32 v26, v64, v65
  v_add_f32 v27, v66, v67
  v_add_f32 v26, v26, v27
  v_add_f32 v225, v225, v26
  v_fma_f32 v68, v68, s41, -v224
  v_fma_f32 v69, v69, s41, -v224
  v_fma_f32 v70, v70, s41, -v224
  v_fma_f32 v71, v71, s41, -v224
  v_exp_f32 v68, v68
  v_exp_f32 v69, v69
  v_exp_f32 v70, v70
  v_exp_f32 v71, v71
  v_cvt_pk_bf16_f32 v34, v68, v69
  v_cvt_pk_bf16_f32 v35, v70, v71
  v_add_f32 v26, v68, v69
  v_add_f32 v27, v70, v71
  v_add_f32 v26, v26, v27
  v_add_f32 v225, v225, v26
  s_waitcnt vmcnt(5)
  buffer_load_dwordx4 v6, s[8:11], s39 offen offset:2048 nt lds
  v_fma_f32 v72, v72, s41, -v224
  v_fma_f32 v73, v73, s41, -v224
  v_fma_f32 v74, v74, s41, -v224
  v_fma_f32 v75, v75, s41, -v224
  v_exp_f32 v72, v72
  v_exp_f32 v73, v73
  v_exp_f32 v74, v74
  v_exp_f32 v75, v75
  v_cvt_pk_bf16_f32 v36, v72, v73
  v_cvt_pk_bf16_f32 v37, v74, v75
  v_add_f32 v26, v72, v73
  v_add_f32 v27, v74, v75
  v_add_f32 v26, v26, v27
  v_add_f32 v225, v225, v26
  v_fma_f32 v76, v76, s41, -v224
  v_fma_f32 v77, v77, s41, -v224
  v_fma_f32 v78, v78, s41, -v224
  v_fma_f32 v79, v79, s41, -v224
  v_exp_f32 v76, v76
  v_exp_f32 v77, v77
  v_exp_f32 v78, v78
  v_exp_f32 v79, v79
  v_cvt_pk_bf16_f32 v38, v76, v77
  v_cvt_pk_bf16_f32 v39, v78, v79
  v_add_f32 v26, v76, v77
  v_add_f32 v27, v78, v79
  v_add_f32 v26, v26, v27
  v_add_f32 v225, v225, v26
  s_waitcnt vmcnt(5)
  buffer_load_dwordx4 v7, s[8:11], s39 offen offset:3072 nt lds
  v_fma_f32 v80, v80, s41, -v224
  v_fma_f32 v81, v81, s41, -v224
  v_fma_f32 v82, v82, s41, -v224
  v_fma_f32 v83, v83, s41, -v224
  v_exp_f32 v80, v80
  v_exp_f32 v81, v81
  v_exp_f32 v82, v82
  v_exp_f32 v83, v83
  v_cvt_pk_bf16_f32 v40, v80, v81
  v_cvt_pk_bf16_f32 v41, v82, v83
  v_add_f32 v26, v80, v81
  v_add_f32 v27, v82, v83
  v_add_f32 v26, v26, v27
  v_add_f32 v225, v225, v26
  v_fma_f32 v84, v84, s41, -v224
  v_fma_f32 v85, v85, s41, -v224
  v_fma_f32 v86, v86, s41, -v224
  v_fma_f32 v87, v87, s41, -v224
  v_exp_f32 v84, v84
  v_exp_f32 v85, v85
  v_exp_f32 v86, v86
  v_exp_f32 v87, v87
  v_cvt_pk_bf16_f32 v42, v84, v85
  v_cvt_pk_bf16_f32 v43, v86, v87
  v_add_f32 v26, v84, v85
  v_add_f32 v27, v86, v87
  v_add_f32 v26, v26, v27
  v_add_f32 v225, v225, v26
  s_waitcnt vmcnt(5)
  s_add_u32 s39, s68, 49152
  s_add_u32 m0, s38, 4096
  s_nop 0
  buffer_load_dwordx4 v4, s[8:11], s39 offen offset:0 nt lds
  v_fma_f32 v88, v88, s41, -v224
  v_fma_f32 v89, v89, s41, -v224
  v_fma_f32 v90, v90, s41, -v224
  v_fma_f32 v91, v91, s41, -v224
  v_exp_f32 v88, v88
  v_exp_f32 v89, v89
  v_exp_f32 v90, v90
  v_exp_f32 v91, v91
  v_cvt_pk_bf16_f32 v44, v88, v89
  v_cvt_pk_bf16_f32 v45, v90, v91
  v_add_f32 v26, v88, v89
  v_add_f32 v27, v90, v91
  v_add_f32 v26, v26, v27
  v_add_f32 v225, v225, v26
  v_fma_f32 v92, v92, s41, -v224
  v_fma_f32 v93, v93, s41, -v224
  v_fma_f32 v94, v94, s41, -v224
  v_fma_f32 v95, v95, s41, -v224
  v_exp_f32 v92, v92
  v_exp_f32 v93, v93
  v_exp_f32 v94, v94
  v_exp_f32 v95, v95
  v_cvt_pk_bf16_f32 v46, v92, v93
  v_cvt_pk_bf16_f32 v47, v94, v95
  v_add_f32 v26, v92, v93
  v_add_f32 v27, v94, v95
  v_add_f32 v26, v26, v27
  v_add_f32 v225, v225, v26
  s_waitcnt vmcnt(5)
  buffer_load_dwordx4 v5, s[8:11], s39 offen offset:1024 nt lds
  v_add_f32_dpp v225, v225, v225 row_ror:8 row_mask:0xf bank_mask:0xf
  v_mov_b32 v26, v225
  s_nop 1
  v_permlane16_swap_b32 v225, v26
  v_add_f32 v225, v225, v26
  v_mov_b32 v26, v225
  s_nop 1
  v_permlane32_swap_b32 v225, v26
  v_add_f32 v225, v225, v26
  v_lshl_add_u32 v26, v1, 2, v2
  v_lshl_add_u32 v26, s3, 6, v26
  s_mov_b32 exec_lo, 0xff
  s_mov_b32 exec_hi, 0x0
  ds_write_b32 v26, v224 offset:5376
  ds_write_b32 v26, v225 offset:5408
  s_mov_b64 exec, 1
  ds_add_u32 v2, v3 offset:5780
  s_mov_b64 exec, -1
  s_waitcnt vmcnt(5)
  buffer_load_dwordx4 v6, s[8:11], s39 offen offset:2048 nt lds
  ds_read_b64_tr_b16 v[160:161], v16 offset:8192
  ds_read_b64_tr_b16 v[164:165], v17 offset:8192
  ds_read_b64_tr_b16 v[168:169], v18 offset:8192
  ds_read_b64_tr_b16 v[172:173], v19 offset:8192
  ds_read_b64_tr_b16 v[176:177], v20 offset:8192
  ds_read_b64_tr_b16 v[180:181], v21 offset:8192
  ds_read_b64_tr_b16 v[184:185], v22 offset:8192
  ds_read_b64_tr_b16 v[188:189], v23 offset:8192
  ds_read_b64_tr_b16 v[162:163], v16 offset:12288
  ds_read_b64_tr_b16 v[166:167], v17 offset:12288
  ds_read_b64_tr_b16 v[170:171], v18 offset:12288
  ds_read_b64_tr_b16 v[174:175], v19 offset:12288
  ds_read_b64_tr_b16 v[178:179], v20 offset:12288
  ds_read_b64_tr_b16 v[182:183], v21 offset:12288
  ds_read_b64_tr_b16 v[186:187], v22 offset:12288
  ds_read_b64_tr_b16 v[190:191], v23 offset:12288
  s_waitcnt lgkmcnt(7)
  v_mfma_f32_16x16x32_bf16 v[96:99], v[160:163], v[32:35], 0
  s_waitcnt lgkmcnt(6)
  v_mfma_f32_16x16x32_bf16 v[100:103], v[164:167], v[32:35], 0
  s_waitcnt lgkmcnt(5)
  v_mfma_f32_16x16x32_bf16 v[104:107], v[168:171], v[32:35], 0
  s_waitcnt lgkmcnt(4)
  v_mfma_f32_16x16x32_bf16 v[108:111], v[172:175], v[32:35], 0
  s_waitcnt lgkmcnt(3)
  v_mfma_f32_16x16x32_bf16 v[112:115], v[176:179], v[32:35], 0
  s_waitcnt lgkmcnt(2)
  v_mfma_f32_16x16x32_bf16 v[116:119], v[180:183], v[32:35], 0
  s_waitcnt lgkmcnt(1)
  v_mfma_f32_16x16x32_bf16 v[120:123], v[184:187], v[32:35], 0
  s_waitcnt lgkmcnt(0)
  v_mfma_f32_16x16x32_bf16 v[124:127], v[188:191], v[32:35], 0
  s_waitcnt vmcnt(5)
  buffer_load_dwordx4 v7, s[8:11], s39 offen offset:3072 nt lds
  s_waitcnt vmcnt(5)
  s_add_u32 s39, s68, 65536
  s_add_u32 m0, s38, 16384
  s_nop 0
  buffer_load_dwordx4 v4, s[8:11], s39 offen offset:0 nt lds
  s_waitcnt vmcnt(5)
  buffer_load_dwordx4 v5, s[8:11], s39 offen offset:1024 nt lds
  s_waitcnt vmcnt(5)
  buffer_load_dwordx4 v6, s[8:11], s39 offen offset:2048 nt lds
  s_waitcnt vmcnt(5)
  buffer_load_dwordx4 v7, s[8:11], s39 offen offset:3072 nt lds
  s_waitcnt vmcnt(5)
  s_add_u32 s39, s68, 98304
  s_add_u32 m0, s38, 20480
  s_nop 0
  buffer_load_dwordx4 v4, s[8:11], s39 offen offset:0 nt lds
  s_mov_b32 s69, 524288
W_5:
  ds_read_b32 v26, v2 offset:5780
  s_waitcnt lgkmcnt(0)
  v_readfirstlane_b32 s30, v26
  s_nop 0
  s_cmp_ge_u32 s30, 4
  s_cbranch_scc1 WD_6
  s_sleep 1
  s_sub_u32 s69, s69, 1
  s_cbranch_scc0 W_5
WD_6:
  s_cmp_lg_u32 s3, 0
  s_cbranch_scc1 MP_7
  v_and_b32 v72, 7, v1
  v_lshl_add_u32 v27, v72, 2, v2
  ds_read_b32 v64, v27 offset:5376
  ds_read_b32 v65, v27 offset:5440
  ds_read_b32 v66, v27 offset:5504
  ds_read_b32 v67, v27 offset:5568
  ds_read_b32 v68, v27 offset:5408
  ds_read_b32 v69, v27 offset:5472
  ds_read_b32 v70, v27 offset:5536
  ds_read_b32 v71, v27 offset:5600
  s_waitcnt lgkmcnt(0)
  v_max3_f32 v26, v64, v65, v66
  v_max_f32 v26, v26, v67
  v_and_b32 v26, v247, v26
  v_sub_f32 v64, v64, v26
  v_sub_f32 v65, v65, v26
  v_sub_f32 v66, v66, v26
  v_sub_f32 v67, v67, v26
  v_exp_f32 v64, v64
  v_exp_f32 v65, v65
  v_exp_f32 v66, v66
  v_exp_f32 v67, v67
  v_or_b32 v76, s86, v26
  v_mul_f32 v77, v64, v68
  v_fmac_f32 v77, v65, v69
  v_fmac_f32 v77, v66, v70
  v_fmac_f32 v77, v67, v71
  v_and_or_b32 v77, v77, v247, s86
  v_mov_b32 v78, s62
  v_mov_b32 v79, s86
  v_lshlrev_b32 v72, 4, v72
  s_lshl_b32 s30, s2, 7
  s_add_u32 s30, s30, 262144
  s_mov_b32 exec_lo, 0xff
  s_mov_b32 exec_hi, 0x0
  buffer_store_dwordx4 v[76:79], v72, s[12:15], s30 offen sc1
  s_mov_b64 exec, -1
MP_7:
  s_waitcnt vmcnt(5)
  buffer_load_dwordx4 v5, s[8:11], s39 offen offset:1024 nt lds
  ds_read_b64_tr_b16 v[160:161], v16 offset:0
  ds_read_b64_tr_b16 v[164:165], v17 offset:0
  ds_read_b64_tr_b16 v[168:169], v18 offset:0
  ds_read_b64_tr_b16 v[172:173], v19 offset:0
  ds_read_b64_tr_b16 v[176:177], v20 offset:0
  ds_read_b64_tr_b16 v[180:181], v21 offset:0
  ds_read_b64_tr_b16 v[184:185], v22 offset:0
  ds_read_b64_tr_b16 v[188:189], v23 offset:0
  ds_read_b64_tr_b16 v[162:163], v16 offset:4096
  ds_read_b64_tr_b16 v[166:167], v17 offset:4096
  ds_read_b64_tr_b16 v[170:171], v18 offset:4096
  ds_read_b64_tr_b16 v[174:175], v19 offset:4096
  ds_read_b64_tr_b16 v[178:179], v20 offset:4096
  ds_read_b64_tr_b16 v[182:183], v21 offset:4096
  ds_read_b64_tr_b16 v[186:187], v22 offset:4096
  ds_read_b64_tr_b16 v[190:191], v23 offset:4096
  s_waitcnt lgkmcnt(7)
  v_mfma_f32_16x16x32_bf16 v[128:131], v[160:163], v[32:35], 0
  s_waitcnt lgkmcnt(6)
  v_mfma_f32_16x16x32_bf16 v[132:135], v[164:167], v[32:35], 0
  s_waitcnt lgkmcnt(5)
  v_mfma_f32_16x16x32_bf16 v[136:139], v[168:171], v[32:35], 0
  s_waitcnt lgkmcnt(4)
  v_mfma_f32_16x16x32_bf16 v[140:143], v[172:175], v[32:35], 0
  s_waitcnt lgkmcnt(3)
  v_mfma_f32_16x16x32_bf16 v[144:147], v[176:179], v[32:35], 0
  s_waitcnt lgkmcnt(2)
  v_mfma_f32_16x16x32_bf16 v[148:151], v[180:183], v[32:35], 0
  s_waitcnt lgkmcnt(1)
  v_mfma_f32_16x16x32_bf16 v[152:155], v[184:187], v[32:35], 0
  s_waitcnt lgkmcnt(0)
  v_mfma_f32_16x16x32_bf16 v[156:159], v[188:191], v[32:35], 0
  s_waitcnt vmcnt(5)
  buffer_load_dwordx4 v6, s[8:11], s39 offen offset:2048 nt lds
  s_waitcnt vmcnt(5)
  buffer_load_dwordx4 v7, s[8:11], s39 offen offset:3072 nt lds
  s_waitcnt vmcnt(5)
  s_add_u32 s39, s68, 81920
  s_add_u32 m0, s38, 0
  s_nop 0
  buffer_load_dwordx4 v4, s[8:11], s39 offen offset:0 nt lds
  v_lshrrev_b32 v232, 5, v0
  v_lshl_add_u32 v27, v232, 2, v2
  ds_read_b32 v228, v27 offset:5376
  ds_read_b32 v229, v27 offset:5440
  ds_read_b32 v230, v27 offset:5504
  ds_read_b32 v231, v27 offset:5568
  s_waitcnt lgkmcnt(0)
  v_max3_f32 v26, v228, v229, v230
  v_max_f32 v26, v26, v231
  v_and_b32 v26, v247, v26
  v_sub_f32 v228, v228, v26
  v_sub_f32 v229, v229, v26
  v_sub_f32 v230, v230, v26
  v_sub_f32 v231, v231, v26
  v_exp_f32 v228, v228
  v_exp_f32 v229, v229
  v_exp_f32 v230, v230
  v_exp_f32 v231, v231
  v_mul_u32_u24 v26, 528, v232
  v_and_b32 v27, 31, v0
  v_lshl_add_u32 v232, v27, 4, v26
  v_add_u32 v233, 49152, v232
  v_and_b32 v234, 15, v0
  v_lshlrev_b32 v234, 4, v234
  v_lshrrev_b32 v26, 4, v0
  v_lshl_add_u32 v234, v26, 14, v234
  s_lshr_b32 s45, s2, 6
  s_lshl_b32 s45, s45, 18
  s_and_b32 s30, s2, 63
  s_lshl_b32 s30, s30, 8
  s_add_u32 s45, s45, s30
  s_add_u32 s45, s45, 1048576
  s_waitcnt vmcnt(5)
  buffer_load_dwordx4 v5, s[8:11], s39 offen offset:1024 nt lds
  s_waitcnt vmcnt(5)
  buffer_load_dwordx4 v6, s[8:11], s39 offen offset:2048 nt lds
  s_waitcnt vmcnt(5)
  buffer_load_dwordx4 v7, s[8:11], s39 offen offset:3072 nt lds
  s_waitcnt vmcnt(5)
  s_add_u32 s39, s68, 114688
  s_add_u32 m0, s38, 4096
  s_nop 0
  buffer_load_dwordx4 v4, s[8:11], s39 offen offset:0 nt lds
  s_waitcnt vmcnt(5)
  buffer_load_dwordx4 v5, s[8:11], s39 offen offset:1024 nt lds
  ds_read_b64_tr_b16 v[160:161], v16 offset:16384
  ds_read_b64_tr_b16 v[164:165], v17 offset:16384
  ds_read_b64_tr_b16 v[168:169], v18 offset:16384
  ds_read_b64_tr_b16 v[172:173], v19 offset:16384
  ds_read_b64_tr_b16 v[176:177], v20 offset:16384
  ds_read_b64_tr_b16 v[180:181], v21 offset:16384
  ds_read_b64_tr_b16 v[184:185], v22 offset:16384
  ds_read_b64_tr_b16 v[188:189], v23 offset:16384
  ds_read_b64_tr_b16 v[162:163], v16 offset:20480
  ds_read_b64_tr_b16 v[166:167], v17 offset:20480
  ds_read_b64_tr_b16 v[170:171], v18 offset:20480
  ds_read_b64_tr_b16 v[174:175], v19 offset:20480
  ds_read_b64_tr_b16 v[178:179], v20 offset:20480
  ds_read_b64_tr_b16 v[182:183], v21 offset:20480
  ds_read_b64_tr_b16 v[186:187], v22 offset:20480
  ds_read_b64_tr_b16 v[190:191], v23 offset:20480
  s_waitcnt lgkmcnt(7)
  v_mfma_f32_16x16x32_bf16 v[96:99], v[160:163], v[36:39], v[96:99]
  s_waitcnt lgkmcnt(6)
  v_mfma_f32_16x16x32_bf16 v[100:103], v[164:167], v[36:39], v[100:103]
  s_waitcnt lgkmcnt(5)
  v_mfma_f32_16x16x32_bf16 v[104:107], v[168:171], v[36:39], v[104:107]
  s_waitcnt lgkmcnt(4)
  v_mfma_f32_16x16x32_bf16 v[108:111], v[172:175], v[36:39], v[108:111]
  s_waitcnt lgkmcnt(3)
  v_mfma_f32_16x16x32_bf16 v[112:115], v[176:179], v[36:39], v[112:115]
  s_waitcnt lgkmcnt(2)
  v_mfma_f32_16x16x32_bf16 v[116:119], v[180:183], v[36:39], v[116:119]
  s_waitcnt lgkmcnt(1)
  v_mfma_f32_16x16x32_bf16 v[120:123], v[184:187], v[36:39], v[120:123]
  s_waitcnt lgkmcnt(0)
  v_mfma_f32_16x16x32_bf16 v[124:127], v[188:191], v[36:39], v[124:127]
  s_waitcnt vmcnt(5)
  buffer_load_dwordx4 v6, s[8:11], s39 offen offset:2048 nt lds
  s_waitcnt vmcnt(5)
  buffer_load_dwordx4 v7, s[8:11], s39 offen offset:3072 nt lds
  s_waitcnt vmcnt(5)
  s_add_u32 s39, s68, 131072
  s_add_u32 m0, s38, 8192
  s_nop 0
  buffer_load_dwordx4 v4, s[8:11], s39 offen offset:0 nt lds
  s_waitcnt vmcnt(5)
  buffer_load_dwordx4 v5, s[8:11], s39 offen offset:1024 nt lds
  s_waitcnt vmcnt(5)
  buffer_load_dwordx4 v6, s[8:11], s39 offen offset:2048 nt lds
  s_waitcnt vmcnt(5)
  buffer_load_dwordx4 v7, s[8:11], s39 offen offset:3072 nt lds
  s_waitcnt vmcnt(5)
  s_add_u32 s39, s68, 163840
  s_add_u32 m0, s38, 12288
  s_nop 0
  buffer_load_dwordx4 v4, s[8:11], s39 offen offset:0 nt lds
  s_waitcnt vmcnt(5)
  buffer_load_dwordx4 v5, s[8:11], s39 offen offset:1024 nt lds
  ds_read_b64_tr_b16 v[160:161], v16 offset:0
  ds_read_b64_tr_b16 v[164:165], v17 offset:0
  ds_read_b64_tr_b16 v[168:169], v18 offset:0
  ds_read_b64_tr_b16 v[172:173], v19 offset:0
  ds_read_b64_tr_b16 v[176:177], v20 offset:0
  ds_read_b64_tr_b16 v[180:181], v21 offset:0
  ds_read_b64_tr_b16 v[184:185], v22 offset:0
  ds_read_b64_tr_b16 v[188:189], v23 offset:0
  ds_read_b64_tr_b16 v[162:163], v16 offset:4096
  ds_read_b64_tr_b16 v[166:167], v17 offset:4096
  ds_read_b64_tr_b16 v[170:171], v18 offset:4096
  ds_read_b64_tr_b16 v[174:175], v19 offset:4096
  ds_read_b64_tr_b16 v[178:179], v20 offset:4096
  ds_read_b64_tr_b16 v[182:183], v21 offset:4096
  ds_read_b64_tr_b16 v[186:187], v22 offset:4096
  ds_read_b64_tr_b16 v[190:191], v23 offset:4096
  s_waitcnt lgkmcnt(7)
  v_mfma_f32_16x16x32_bf16 v[128:131], v[160:163], v[36:39], v[128:131]
  s_waitcnt lgkmcnt(6)
  v_mfma_f32_16x16x32_bf16 v[132:135], v[164:167], v[36:39], v[132:135]
  s_waitcnt lgkmcnt(5)
  v_mfma_f32_16x16x32_bf16 v[136:139], v[168:171], v[36:39], v[136:139]
  s_waitcnt lgkmcnt(4)
  v_mfma_f32_16x16x32_bf16 v[140:143], v[172:175], v[36:39], v[140:143]
  s_waitcnt lgkmcnt(3)
  v_mfma_f32_16x16x32_bf16 v[144:147], v[176:179], v[36:39], v[144:147]
  s_waitcnt lgkmcnt(2)
  v_mfma_f32_16x16x32_bf16 v[148:151], v[180:183], v[36:39], v[148:151]
  s_waitcnt lgkmcnt(1)
  v_mfma_f32_16x16x32_bf16 v[152:155], v[184:187], v[36:39], v[152:155]
  s_waitcnt lgkmcnt(0)
  v_mfma_f32_16x16x32_bf16 v[156:159], v[188:191], v[36:39], v[156:159]
  s_waitcnt vmcnt(5)
  buffer_load_dwordx4 v6, s[8:11], s39 offen offset:2048 nt lds
  s_waitcnt vmcnt(5)
  buffer_load_dwordx4 v7, s[8:11], s39 offen offset:3072 nt lds
  s_waitcnt vmcnt(5)
  s_add_u32 s39, s68, 147456
  s_add_u32 m0, s38, 16384
  s_nop 0
  buffer_load_dwordx4 v4, s[8:11], s39 offen offset:0 nt lds
  s_waitcnt vmcnt(5)
  buffer_load_dwordx4 v5, s[8:11], s39 offen offset:1024 nt lds
  s_waitcnt vmcnt(5)
  buffer_load_dwordx4 v6, s[8:11], s39 offen offset:2048 nt lds
  s_waitcnt vmcnt(5)
  buffer_load_dwordx4 v7, s[8:11], s39 offen offset:3072 nt lds
  s_waitcnt vmcnt(5)
  s_add_u32 s39, s68, 180224
  s_add_u32 m0, s38, 20480
  s_nop 0
  buffer_load_dwordx4 v4, s[8:11], s39 offen offset:0 nt lds
  s_waitcnt vmcnt(5)
  buffer_load_dwordx4 v5, s[8:11], s39 offen offset:1024 nt lds
  ds_read_b64_tr_b16 v[160:161], v16 offset:8192
  ds_read_b64_tr_b16 v[164:165], v17 offset:8192
  ds_read_b64_tr_b16 v[168:169], v18 offset:8192
  ds_read_b64_tr_b16 v[172:173], v19 offset:8192
  ds_read_b64_tr_b16 v[176:177], v20 offset:8192
  ds_read_b64_tr_b16 v[180:181], v21 offset:8192
  ds_read_b64_tr_b16 v[184:185], v22 offset:8192
  ds_read_b64_tr_b16 v[188:189], v23 offset:8192
  ds_read_b64_tr_b16 v[162:163], v16 offset:12288
  ds_read_b64_tr_b16 v[166:167], v17 offset:12288
  ds_read_b64_tr_b16 v[170:171], v18 offset:12288
  ds_read_b64_tr_b16 v[174:175], v19 offset:12288
  ds_read_b64_tr_b16 v[178:179], v20 offset:12288
  ds_read_b64_tr_b16 v[182:183], v21 offset:12288
  ds_read_b64_tr_b16 v[186:187], v22 offset:12288
  ds_read_b64_tr_b16 v[190:191], v23 offset:12288
  s_waitcnt lgkmcnt(7)
  v_mfma_f32_16x16x32_bf16 v[96:99], v[160:163], v[40:43], v[96:99]
  s_waitcnt lgkmcnt(6)
  v_mfma_f32_16x16x32_bf16 v[100:103], v[164:167], v[40:43], v[100:103]
  s_waitcnt lgkmcnt(5)
  v_mfma_f32_16x16x32_bf16 v[104:107], v[168:171], v[40:43], v[104:107]
  s_waitcnt lgkmcnt(4)
  v_mfma_f32_16x16x32_bf16 v[108:111], v[172:175], v[40:43], v[108:111]
  s_waitcnt lgkmcnt(3)
  v_mfma_f32_16x16x32_bf16 v[112:115], v[176:179], v[40:43], v[112:115]
  s_waitcnt lgkmcnt(2)
  v_mfma_f32_16x16x32_bf16 v[116:119], v[180:183], v[40:43], v[116:119]
  s_waitcnt lgkmcnt(1)
  v_mfma_f32_16x16x32_bf16 v[120:123], v[184:187], v[40:43], v[120:123]
  s_waitcnt lgkmcnt(0)
  v_mfma_f32_16x16x32_bf16 v[124:127], v[188:191], v[40:43], v[124:127]
  s_waitcnt vmcnt(6)
  buffer_load_dwordx4 v6, s[8:11], s39 offen offset:2048 nt lds
  s_waitcnt vmcnt(6)
  buffer_load_dwordx4 v7, s[8:11], s39 offen offset:3072 nt lds
  s_waitcnt vmcnt(6)
  s_add_u32 s39, s68, 196608
  s_add_u32 m0, s38, 0
  s_nop 0
  buffer_load_dwordx4 v4, s[8:11], s39 offen offset:0 nt lds
  s_cmp_lg_u32 s3, 0
  s_cbranch_scc1 RK_8
  s_lshl_b32 s30, s42, 12
  s_add_u32 s30, s30, 393216
  v_mov_b32 v72, 1
  v_mov_b32 v73, 0
  s_mov_b64 exec, 1
  buffer_atomic_add v72, v73, s[12:15], s30 offen sc0 sc1
  s_mov_b64 exec, -1
RK_8:
  s_waitcnt vmcnt(6)
  buffer_load_dwordx4 v5, s[8:11], s39 offen offset:1024 nt lds
  s_waitcnt vmcnt(6)
  buffer_load_dwordx4 v6, s[8:11], s39 offen offset:2048 nt lds
  s_waitcnt vmcnt(6)
  buffer_load_dwordx4 v7, s[8:11], s39 offen offset:3072 nt lds
  s_waitcnt vmcnt(6)
  s_add_u32 s39, s68, 229376
  s_add_u32 m0, s38, 4096
  s_nop 0
  buffer_load_dwordx4 v4, s[8:11], s39 offen offset:0 nt lds
  s_waitcnt vmcnt(6)
  buffer_load_dwordx4 v5, s[8:11], s39 offen offset:1024 nt lds
  s_waitcnt vmcnt(6)
  buffer_load_dwordx4 v6, s[8:11], s39 offen offset:2048 nt lds
  ds_read_b64_tr_b16 v[160:161], v16 offset:16384
  ds_read_b64_tr_b16 v[164:165], v17 offset:16384
  ds_read_b64_tr_b16 v[168:169], v18 offset:16384
  ds_read_b64_tr_b16 v[172:173], v19 offset:16384
  ds_read_b64_tr_b16 v[176:177], v20 offset:16384
  ds_read_b64_tr_b16 v[180:181], v21 offset:16384
  ds_read_b64_tr_b16 v[184:185], v22 offset:16384
  ds_read_b64_tr_b16 v[188:189], v23 offset:16384
  ds_read_b64_tr_b16 v[162:163], v16 offset:20480
  ds_read_b64_tr_b16 v[166:167], v17 offset:20480
  ds_read_b64_tr_b16 v[170:171], v18 offset:20480
  ds_read_b64_tr_b16 v[174:175], v19 offset:20480
  ds_read_b64_tr_b16 v[178:179], v20 offset:20480
  ds_read_b64_tr_b16 v[182:183], v21 offset:20480
  ds_read_b64_tr_b16 v[186:187], v22 offset:20480
  ds_read_b64_tr_b16 v[190:191], v23 offset:20480
  s_waitcnt lgkmcnt(7)
  v_mfma_f32_16x16x32_bf16 v[128:131], v[160:163], v[40:43], v[128:131]
  s_waitcnt lgkmcnt(6)
  v_mfma_f32_16x16x32_bf16 v[132:135], v[164:167], v[40:43], v[132:135]
  s_waitcnt lgkmcnt(5)
  v_mfma_f32_16x16x32_bf16 v[136:139], v[168:171], v[40:43], v[136:139]
  s_waitcnt lgkmcnt(4)
  v_mfma_f32_16x16x32_bf16 v[140:143], v[172:175], v[40:43], v[140:143]
  s_waitcnt lgkmcnt(3)
  v_mfma_f32_16x16x32_bf16 v[144:147], v[176:179], v[40:43], v[144:147]
  s_waitcnt lgkmcnt(2)
  v_mfma_f32_16x16x32_bf16 v[148:151], v[180:183], v[40:43], v[148:151]
  s_waitcnt lgkmcnt(1)
  v_mfma_f32_16x16x32_bf16 v[152:155], v[184:187], v[40:43], v[152:155]
  s_waitcnt lgkmcnt(0)
  v_mfma_f32_16x16x32_bf16 v[156:159], v[188:191], v[40:43], v[156:159]
  s_waitcnt vmcnt(6)
  buffer_load_dwordx4 v7, s[8:11], s39 offen offset:3072 nt lds
  s_waitcnt vmcnt(6)
  s_add_u32 s39, s68, 212992
  s_add_u32 m0, s38, 8192
  s_nop 0
  buffer_load_dwordx4 v4, s[8:11], s39 offen offset:0 nt lds
  s_cmp_lg_u32 s3, 0
  s_cbranch_scc1 RK_9
  s_mov_b64 exec, 1
  v_add_u32 v72, 1, v72
  ds_write_b32 v2, v72 offset:5820
  s_mov_b64 exec, -1
RK_9:
  s_waitcnt vmcnt(6)
  buffer_load_dwordx4 v5, s[8:11], s39 offen offset:1024 nt lds
  s_waitcnt vmcnt(6)
  buffer_load_dwordx4 v6, s[8:11], s39 offen offset:2048 nt lds
  s_waitcnt vmcnt(6)
  buffer_load_dwordx4 v7, s[8:11], s39 offen offset:3072 nt lds
  s_waitcnt vmcnt(6)
  s_add_u32 s39, s68, 245760
  s_add_u32 m0, s38, 12288
  s_nop 0
  buffer_load_dwordx4 v4, s[8:11], s39 offen offset:0 nt lds
  s_waitcnt vmcnt(6)
  buffer_load_dwordx4 v5, s[8:11], s39 offen offset:1024 nt lds
  s_waitcnt vmcnt(6)
  buffer_load_dwordx4 v6, s[8:11], s39 offen offset:2048 nt lds
  ds_read_b64_tr_b16 v[160:161], v16 offset:0
  ds_read_b64_tr_b16 v[164:165], v17 offset:0
  ds_read_b64_tr_b16 v[168:169], v18 offset:0
  ds_read_b64_tr_b16 v[172:173], v19 offset:0
  ds_read_b64_tr_b16 v[176:177], v20 offset:0
  ds_read_b64_tr_b16 v[180:181], v21 offset:0
  ds_read_b64_tr_b16 v[184:185], v22 offset:0
  ds_read_b64_tr_b16 v[188:189], v23 offset:0
  ds_read_b64_tr_b16 v[162:163], v16 offset:4096
  ds_read_b64_tr_b16 v[166:167], v17 offset:4096
  ds_read_b64_tr_b16 v[170:171], v18 offset:4096
  ds_read_b64_tr_b16 v[174:175], v19 offset:4096
  ds_read_b64_tr_b16 v[178:179], v20 offset:4096
  ds_read_b64_tr_b16 v[182:183], v21 offset:4096
  ds_read_b64_tr_b16 v[186:187], v22 offset:4096
  ds_read_b64_tr_b16 v[190:191], v23 offset:4096
  s_waitcnt lgkmcnt(7)
  v_mfma_f32_16x16x32_bf16 v[96:99], v[160:163], v[44:47], v[96:99]
  s_waitcnt lgkmcnt(6)
  v_mfma_f32_16x16x32_bf16 v[100:103], v[164:167], v[44:47], v[100:103]
  s_waitcnt lgkmcnt(5)
  v_mfma_f32_16x16x32_bf16 v[104:107], v[168:171], v[44:47], v[104:107]
  s_waitcnt lgkmcnt(4)
  v_mfma_f32_16x16x32_bf16 v[108:111], v[172:175], v[44:47], v[108:111]
  s_waitcnt lgkmcnt(3)
  v_mfma_f32_16x16x32_bf16 v[112:115], v[176:179], v[44:47], v[112:115]
  s_waitcnt lgkmcnt(2)
  v_mfma_f32_16x16x32_bf16 v[116:119], v[180:183], v[44:47], v[116:119]
  s_waitcnt lgkmcnt(1)
  v_mfma_f32_16x16x32_bf16 v[120:123], v[184:187], v[44:47], v[120:123]
  s_waitcnt lgkmcnt(0)
  v_mfma_f32_16x16x32_bf16 v[124:127], v[188:191], v[44:47], v[124:127]
  s_waitcnt vmcnt(6)
  buffer_load_dwordx4 v7, s[8:11], s39 offen offset:3072 nt lds
  s_mov_b32 exec_lo, 0xff00ff
  s_mov_b32 exec_hi, 0xff00ff
  ds_write_b128 v31, v[96:99] offset:0
  ds_write_b128 v31, v[100:103] offset:64
  ds_write_b128 v31, v[104:107] offset:128
  ds_write_b128 v31, v[108:111] offset:192
  ds_write_b128 v31, v[112:115] offset:256
  ds_write_b128 v31, v[116:119] offset:320
  ds_write_b128 v31, v[120:123] offset:384
  ds_write_b128 v31, v[124:127] offset:448
  s_mov_b64 exec, -1
  s_mov_b64 exec, 1
  ds_add_u32 v2, v3 offset:5856
  s_mov_b64 exec, -1
  s_mov_b32 s69, 524288
W_15:
  ds_read_b32 v26, v2 offset:5820
  s_waitcnt lgkmcnt(0)
  v_readfirstlane_b32 s30, v26
  s_nop 0
  s_cmp_ge_u32 s30, 1
  s_cbranch_scc1 WD_16
  s_sub_u32 s69, s69, 1
  s_cbranch_scc0 W_15
WD_16:
  s_sub_u32 s33, s30, 1
  s_cmp_ge_u32 s33, 32
  s_cbranch_scc1 M_10
  s_lshr_b32 s44, s33, 1
  s_lshl_b32 s30, s42, 4
  s_add_u32 s44, s44, s30
  s_lshl_b32 s44, s44, 17
  s_lshl_b32 s30, s67, 15
  s_add_u32 s44, s44, s30
  s_and_b32 s30, s33, 1
  s_lshl_b32 s30, s30, 10
  s_add_u32 s44, s44, s30
  s_waitcnt vmcnt(4)
  ds_read_b64_tr_b16 v[160:161], v16 offset:8192
  ds_read_b64_tr_b16 v[164:165], v17 offset:8192
  ds_read_b64_tr_b16 v[168:169], v18 offset:8192
  ds_read_b64_tr_b16 v[172:173], v19 offset:8192
  ds_read_b64_tr_b16 v[176:177], v20 offset:8192
  ds_read_b64_tr_b16 v[180:181], v21 offset:8192
  ds_read_b64_tr_b16 v[184:185], v22 offset:8192
  ds_read_b64_tr_b16 v[188:189], v23 offset:8192
  s_waitcnt vmcnt(2)
  s_add_u32 s32, s44, 0
  s_add_u32 m0, s59, 98304
  s_nop 0
  buffer_load_dwordx4 v238, s[20:23], s32 offen nt lds
  s_waitcnt vmcnt(2)
  s_add_u32 s32, s44, 4096
  s_add_u32 m0, s59, 99328
  s_nop 0
  buffer_load_dwordx4 v239, s[20:23], s32 offen nt lds
  v_and_b32 v27, 8, v1
  v_xor_b32 v27, 8, v27
  v_mul_u32_u24 v27, 544, v27
  v_add_u32 v31, v31, v27
  s_mov_b32 s69, 524288
W_17:
  ds_read_b32 v26, v2 offset:5856
  s_waitcnt lgkmcnt(0)
  v_readfirstlane_b32 s30, v26
  s_nop 0
  s_cmp_ge_u32 s30, 4
  s_cbranch_scc1 WD_18
  s_sub_u32 s69, s69, 1
  s_cbranch_scc0 W_17
WD_18:
  ds_read_b128 v[192:195], v232 offset:0
  ds_read_b128 v[196:199], v232 offset:24576
  ds_read_b128 v[200:203], v233 offset:0
  ds_read_b128 v[204:207], v233 offset:24576
  s_waitcnt lgkmcnt(3)
  v_pk_mul_f32 v[208:209], v[192:193], v[228:229] op_sel:[0,0] op_sel_hi:[1,0]
  v_pk_mul_f32 v[210:211], v[194:195], v[228:229] op_sel:[0,0] op_sel_hi:[1,0]
  s_waitcnt lgkmcnt(2)
  v_pk_fma_f32 v[208:209], v[196:197], v[228:229], v[208:209] op_sel:[0,1,0] op_sel_hi:[1,1,1]
  v_pk_fma_f32 v[210:211], v[198:199], v[228:229], v[210:211] op_sel:[0,1,0] op_sel_hi:[1,1,1]
  s_waitcnt lgkmcnt(1)
  v_pk_fma_f32 v[208:209], v[200:201], v[230:231], v[208:209] op_sel:[0,0,0] op_sel_hi:[1,0,1]
  v_pk_fma_f32 v[210:211], v[202:203], v[230:231], v[210:211] op_sel:[0,0,0] op_sel_hi:[1,0,1]
  s_waitcnt lgkmcnt(0)
  v_pk_fma_f32 v[208:209], v[204:205], v[230:231], v[208:209] op_sel:[0,1,0] op_sel_hi:[1,1,1]
  v_pk_fma_f32 v[210:211], v[206:207], v[230:231], v[210:211] op_sel:[0,1,0] op_sel_hi:[1,1,1]
  s_waitcnt vmcnt(2)
  s_add_u32 s32, s44, 8192
  s_add_u32 m0, s59, 100352
  s_nop 0
  buffer_load_dwordx4 v240, s[20:23], s32 offen nt lds
  ds_read_b64_tr_b16 v[162:163], v16 offset:12288
  ds_read_b64_tr_b16 v[166:167], v17 offset:12288
  ds_read_b64_tr_b16 v[170:171], v18 offset:12288
  ds_read_b64_tr_b16 v[174:175], v19 offset:12288
  ds_read_b64_tr_b16 v[178:179], v20 offset:12288
  ds_read_b64_tr_b16 v[182:183], v21 offset:12288
  ds_read_b64_tr_b16 v[186:187], v22 offset:12288
  ds_read_b64_tr_b16 v[190:191], v23 offset:12288
  s_waitcnt lgkmcnt(7)
  v_mfma_f32_16x16x32_bf16 v[128:131], v[160:163], v[44:47], v[128:131]
  s_waitcnt lgkmcnt(6)
  v_mfma_f32_16x16x32_bf16 v[132:135], v[164:167], v[44:47], v[132:135]
  s_waitcnt lgkmcnt(5)
  v_mfma_f32_16x16x32_bf16 v[136:139], v[168:171], v[44:47], v[136:139]
  s_waitcnt lgkmcnt(4)
  v_mfma_f32_16x16x32_bf16 v[140:143], v[172:175], v[44:47], v[140:143]
  s_waitcnt lgkmcnt(3)
  v_mfma_f32_16x16x32_bf16 v[144:147], v[176:179], v[44:47], v[144:147]
  ds_write_b128 v31, v[128:131] offset:4352
  s_waitcnt lgkmcnt(3)
  v_mfma_f32_16x16x32_bf16 v[148:151], v[180:183], v[44:47], v[148:151]
  ds_write_b128 v31, v[132:135] offset:4416
  s_waitcnt lgkmcnt(3)
  v_mfma_f32_16x16x32_bf16 v[152:155], v[184:187], v[44:47], v[152:155]
  ds_write_b128 v31, v[136:139] offset:4480
  s_waitcnt lgkmcnt(3)
  v_mfma_f32_16x16x32_bf16 v[156:159], v[188:191], v[44:47], v[156:159]
  ds_write_b128 v31, v[140:143] offset:4544
  ds_write_b128 v31, v[144:147] offset:4608
  ds_write_b128 v31, v[148:151] offset:4672
  s_nop 1
  ds_write_b128 v31, v[152:155] offset:4736
  s_nop 1
  ds_write_b128 v31, v[156:159] offset:4800
  s_mov_b64 exec, 1
  ds_add_u32 v2, v3 offset:5784
  s_mov_b64 exec, -1
  s_mov_b32 s69, 524288
W_19:
  ds_read_b32 v26, v2 offset:5784
  s_waitcnt lgkmcnt(0)
  v_readfirstlane_b32 s30, v26
  s_nop 0
  s_cmp_ge_u32 s30, 4
  s_cbranch_scc1 WD_20
  s_sub_u32 s69, s69, 1
  s_cbranch_scc0 W_19
WD_20:
  ds_read_b128 v[192:195], v232 offset:4352
  ds_read_b128 v[196:199], v232 offset:28928
  ds_read_b128 v[200:203], v233 offset:4352
  ds_read_b128 v[204:207], v233 offset:28928
  s_waitcnt lgkmcnt(3)
  v_pk_fma_f32 v[208:209], v[192:193], v[228:229], v[208:209] op_sel:[0,0,0] op_sel_hi:[1,0,1]
  v_pk_fma_f32 v[210:211], v[194:195], v[228:229], v[210:211] op_sel:[0,0,0] op_sel_hi:[1,0,1]
  s_waitcnt lgkmcnt(2)
  v_pk_fma_f32 v[208:209], v[196:197], v[228:229], v[208:209] op_sel:[0,1,0] op_sel_hi:[1,1,1]
  v_pk_fma_f32 v[210:211], v[198:199], v[228:229], v[210:211] op_sel:[0,1,0] op_sel_hi:[1,1,1]
  s_waitcnt lgkmcnt(1)
  v_pk_fma_f32 v[208:209], v[200:201], v[230:231], v[208:209] op_sel:[0,0,0] op_sel_hi:[1,0,1]
  v_pk_fma_f32 v[210:211], v[202:203], v[230:231], v[210:211] op_sel:[0,0,0] op_sel_hi:[1,0,1]
  s_waitcnt lgkmcnt(0)
  v_pk_fma_f32 v[208:209], v[204:205], v[230:231], v[208:209] op_sel:[0,1,0] op_sel_hi:[1,1,1]
  v_pk_fma_f32 v[210:211], v[206:207], v[230:231], v[210:211] op_sel:[0,1,0] op_sel_hi:[1,1,1]
  v_and_or_b32 v208, v208, v247, s62
  v_and_or_b32 v211, v211, v247, s86
  buffer_store_dwordx4 v[208:211], v234, s[12:15], s45 offen sc1
  s_mov_b64 exec, 1
  ds_add_u32 v2, v3 offset:5808
  s_mov_b64 exec, -1
  s_waitcnt vmcnt(2)
  s_add_u32 s32, s44, 12288
  s_add_u32 m0, s59, 101376
  s_nop 0
  buffer_load_dwordx4 v241, s[20:23], s32 offen nt lds
  s_waitcnt vmcnt(2)
  s_add_u32 s32, s44, 16384
  s_add_u32 m0, s59, 102400
  s_nop 0
  buffer_load_dwordx4 v238, s[20:23], s32 offen nt lds
  s_waitcnt vmcnt(2)
  s_add_u32 s32, s44, 20480
  s_add_u32 m0, s59, 103424
  s_nop 0
  buffer_load_dwordx4 v239, s[20:23], s32 offen nt lds
  s_waitcnt vmcnt(2)
  s_add_u32 s32, s44, 24576
  s_add_u32 m0, s59, 104448
  s_nop 0
  buffer_load_dwordx4 v240, s[20:23], s32 offen nt lds
  s_waitcnt vmcnt(2)
  s_add_u32 s32, s44, 28672
  s_add_u32 m0, s59, 105472
  s_nop 0
  buffer_load_dwordx4 v241, s[20:23], s32 offen nt lds
  s_waitcnt vmcnt(7)
  s_add_u32 s32, s44, 512
  s_add_u32 m0, s38, 16384
  s_nop 0
  buffer_load_dwordx4 v238, s[20:23], s32 offen nt lds
  s_waitcnt vmcnt(7)
  s_add_u32 s32, s44, 4608
  s_add_u32 m0, s38, 17408
  s_nop 0
  buffer_load_dwordx4 v239, s[20:23], s32 offen nt lds
  s_waitcnt vmcnt(7)
  s_add_u32 s32, s44, 8704
  s_add_u32 m0, s38, 18432
  s_nop 0
  buffer_load_dwordx4 v240, s[20:23], s32 offen nt lds
  s_waitcnt vmcnt(7)
  s_add_u32 s32, s44, 12800
  s_add_u32 m0, s38, 19456
  s_nop 0
  buffer_load_dwordx4 v241, s[20:23], s32 offen nt lds
  s_waitcnt vmcnt(7)
  s_add_u32 s32, s44, 16896
  s_add_u32 m0, s38, 20480
  s_nop 0
  buffer_load_dwordx4 v238, s[20:23], s32 offen nt lds
  s_waitcnt vmcnt(7)
  s_add_u32 s32, s44, 20992
  s_add_u32 m0, s38, 21504
  s_nop 0
  buffer_load_dwordx4 v239, s[20:23], s32 offen nt lds
  s_waitcnt vmcnt(7)
  s_add_u32 s32, s44, 25088
  s_add_u32 m0, s38, 22528
  s_nop 0
  buffer_load_dwordx4 v240, s[20:23], s32 offen nt lds
  s_waitcnt vmcnt(7)
  s_add_u32 s32, s44, 29184
  s_add_u32 m0, s38, 23552
  s_nop 0
  buffer_load_dwordx4 v241, s[20:23], s32 offen nt lds
  s_mov_b64 exec, 1
  ds_add_u32 v2, v3 offset:5836
  s_mov_b64 exec, -1
  v_lshrrev_b32 v11, 2, v1
  v_lshlrev_b32 v68, 9, v11
  v_and_b32 v74, 7, v11
  v_lshlrev_b32 v74, 1, v74
  v_lshrrev_b32 v75, 1, v1
  v_and_b32 v75, 1, v75
  v_lshl_add_u32 v75, s67, 3, v75
  v_xor_b32 v74, v74, v75
  v_lshl_add_u32 v68, v74, 4, v68
  v_and_b32 v74, 1, v1
  v_lshl_add_u32 v68, v74, 3, v68
  v_add_u32 v68, 16384, v68
  v_xor_b32 v69, 0x20, v68
  v_xor_b32 v70, 0x40, v68
  v_xor_b32 v71, 0x60, v68
  v_mov_b32 v84, v68
  v_add_u32 v88, 49152, v68
  v_mov_b32 v85, v69
  v_add_u32 v89, 49152, v69
  v_mov_b32 v86, v70
  v_add_u32 v90, 49152, v70
  v_mov_b32 v87, v71
  v_add_u32 v91, 49152, v71
  v_mov_b32 v202, 0
  v_mov_b32 v203, 0
  v_mov_b32 v204, 0
  v_mov_b32 v205, 0
  v_mov_b32 v206, 0
  v_mov_b32 v207, 0
  v_mov_b32 v208, 0
  v_mov_b32 v209, 0
  v_mov_b32 v210, 0
  v_mov_b32 v211, 0
  v_mov_b32 v212, 0
  v_mov_b32 v213, 0
  v_mov_b32 v214, 0
  v_mov_b32 v215, 0
  v_mov_b32 v216, 0
  v_mov_b32 v217, 0
  v_mov_b32 v218, 0
  v_mov_b32 v219, 0
  v_mov_b32 v220, 0
  v_mov_b32 v221, 0
  v_mov_b32 v222, 0
  v_mov_b32 v223, 0
  v_mov_b32 v224, 0
  v_mov_b32 v225, 0
  v_mov_b32 v226, 0
  v_mov_b32 v227, 0
  v_mov_b32 v228, 0
  v_mov_b32 v229, 0
  v_mov_b32 v230, 0
  v_mov_b32 v231, 0
  v_mov_b32 v232, 0
  v_mov_b32 v233, 0
  v_lshrrev_b32 v75, 4, v1
  v_lshl_add_u32 v72, v75, 3, v2
  v_add_u32 v72, 4864, v72
  v_lshlrev_b32 v73, 4, v75
  v_lshl_add_u32 v73, v74, 6, v73
  v_and_b32 v74, 2, v1
  v_lshl_add_u32 v73, v74, 12, v73
  s_lshr_b32 s45, s33, 1
  s_lshr_b32 s30, s2, 6
  s_lshl_b32 s30, s30, 4
  s_add_u32 s45, s45, s30
  s_lshl_b32 s45, s45, 7
  s_and_b32 s30, s33, 1
  s_lshl_b32 s30, s30, 17
  s_add_u32 s45, s45, s30
  s_lshl_b32 s30, s67, 14
  s_add_u32 s45, s45, s30
  s_add_u32 s45, s45, 589824
  s_waitcnt vmcnt(0)
  s_mov_b64 exec, 1
  ds_add_u32 v2, v3 offset:5788
  s_mov_b64 exec, -1
  s_mov_b32 s69, 524288
W_21:
  ds_read_b32 v4, v2 offset:5788
  s_waitcnt lgkmcnt(0)
  v_readfirstlane_b32 s30, v4
  s_nop 0
  s_cmp_ge_u32 s30, 4
  s_cbranch_scc1 WD_22
  s_sub_u32 s69, s69, 1
  s_cbranch_scc0 W_21
WD_22:
  ds_read_b64_tr_b16 v[120:121], v84 offset:0
  ds_read_b64_tr_b16 v[122:123], v84 offset:24576
  ds_read_b64_tr_b16 v[124:125], v88 offset:0
  ds_read_b64_tr_b16 v[126:127], v88 offset:24576
  ds_read_b64_tr_b16 v[128:129], v85 offset:0
  ds_read_b64_tr_b16 v[130:131], v85 offset:24576
  ds_read_b64_tr_b16 v[132:133], v89 offset:0
  ds_read_b64_tr_b16 v[134:135], v89 offset:24576
  ds_read_b64_tr_b16 v[136:137], v86 offset:0
  ds_read_b64_tr_b16 v[138:139], v86 offset:24576
  ds_read_b64_tr_b16 v[140:141], v90 offset:0
  ds_read_b64_tr_b16 v[142:143], v90 offset:24576
  ds_read_b64_tr_b16 v[144:145], v87 offset:0
  ds_read_b64_tr_b16 v[146:147], v87 offset:24576
  ds_read_b64_tr_b16 v[148:149], v91 offset:0
  ds_read_b64_tr_b16 v[150:151], v91 offset:24576
  s_waitcnt lgkmcnt(0)
  s_barrier
  s_mov_b32 exec_lo, 0x10001
  s_mov_b32 exec_hi, 0x10001
  ds_read2_b64 v[202:205], v72 offset0:0 offset1:4
  ds_read2_b64 v[206:209], v72 offset0:8 offset1:12
  s_mov_b32 exec_lo, 0x20002
  s_mov_b32 exec_hi, 0x20002
  ds_read2_b64 v[210:213], v72 offset0:0 offset1:4
  ds_read2_b64 v[214:217], v72 offset0:8 offset1:12
  s_mov_b32 exec_lo, 0x40004
  s_mov_b32 exec_hi, 0x40004
  ds_read2_b64 v[218:221], v72 offset0:0 offset1:4
  ds_read2_b64 v[222:225], v72 offset0:8 offset1:12
  s_mov_b32 exec_lo, 0x80008
  s_mov_b32 exec_hi, 0x80008
  ds_read2_b64 v[226:229], v72 offset0:0 offset1:4
  ds_read2_b64 v[230:233], v72 offset0:8 offset1:12
  s_mov_b64 exec, -1
  s_waitcnt lgkmcnt(7)
  v_mfma_f32_16x16x32_bf16 v[24:27], v[120:123], v[202:205], 0
  s_waitcnt lgkmcnt(6)
  v_mfma_f32_16x16x32_bf16 v[24:27], v[124:127], v[206:209], v[24:27]
  s_waitcnt lgkmcnt(5)
  v_mfma_f32_16x16x32_bf16 v[24:27], v[128:131], v[210:213], v[24:27]
  s_waitcnt lgkmcnt(4)
  v_mfma_f32_16x16x32_bf16 v[24:27], v[132:135], v[214:217], v[24:27]
  s_waitcnt lgkmcnt(3)
  v_mfma_f32_16x16x32_bf16 v[24:27], v[136:139], v[218:221], v[24:27]
  s_waitcnt lgkmcnt(2)
  v_mfma_f32_16x16x32_bf16 v[24:27], v[140:143], v[222:225], v[24:27]
  s_waitcnt lgkmcnt(1)
  v_mfma_f32_16x16x32_bf16 v[24:27], v[144:147], v[226:229], v[24:27]
  s_waitcnt lgkmcnt(0)
  v_mfma_f32_16x16x32_bf16 v[24:27], v[148:151], v[230:233], v[24:27]
  s_mov_b32 exec_lo, 0xf000f
  s_mov_b32 exec_hi, 0xf000f
  s_nop 5
  v_and_or_b32 v24, v24, v247, s62
  v_and_or_b32 v27, v27, v247, s86
  buffer_store_dwordx4 v[24:27], v73, s[12:15], s45 offen sc1
  s_mov_b64 exec, -1
  s_branch TD_14
M_10:
  s_sub_u32 s43, s30, 33
  s_cmp_ge_u32 s43, 64
  s_cbranch_scc1 N_11
  s_lshl_b32 s30, s42, 2
  s_add_u32 s30, s30, s67
  s_mul_i32 s46, s30, 786432
  s_lshl_b32 s30, s43, 7
  s_add_u32 s46, s46, s30
  s_add_u32 s46, s46, 4096
  s_lshl_b32 s44, s42, 14
  s_lshl_b32 s30, s43, 8
  s_add_u32 s44, s44, s30
  s_lshl_b32 s30, s67, 6
  s_add_u32 s44, s44, s30
  s_add_u32 s44, s44, 196608
  s_waitcnt vmcnt(5)
  s_cmp_lg_u32 s3, 0
  s_cbranch_scc1 RK_23
  s_lshl_b32 s30, s42, 12
  s_add_u32 s30, s30, 393216
  v_mov_b32 v72, 1
  v_mov_b32 v73, 0
  s_mov_b64 exec, 1
  buffer_atomic_add v72, v73, s[12:15], s30 offen sc0 sc1
  s_mov_b64 exec, -1
RK_23:
  s_add_u32 s32, s46, 0
  s_add_u32 m0, s38, 16384
  s_nop 0
  buffer_load_dwordx4 v236, s[24:27], s32 offen nt lds
  s_waitcnt vmcnt(5)
  s_add_u32 s32, s46, 98304
  s_add_u32 m0, s38, 17408
  s_nop 0
  buffer_load_dwordx4 v236, s[24:27], s32 offen nt lds
  ds_read_b64_tr_b16 v[160:161], v16 offset:8192
  ds_read_b64_tr_b16 v[164:165], v17 offset:8192
  ds_read_b64_tr_b16 v[168:169], v18 offset:8192
  ds_read_b64_tr_b16 v[172:173], v19 offset:8192
  ds_read_b64_tr_b16 v[176:177], v20 offset:8192
  ds_read_b64_tr_b16 v[180:181], v21 offset:8192
  ds_read_b64_tr_b16 v[184:185], v22 offset:8192
  ds_read_b64_tr_b16 v[188:189], v23 offset:8192
  s_waitcnt vmcnt(5)
  s_add_u32 s32, s46, 196608
  s_add_u32 m0, s38, 18432
  s_nop 0
  buffer_load_dwordx4 v236, s[24:27], s32 offen nt lds
  s_waitcnt vmcnt(5)
  s_add_u32 s32, s46, 294912
  s_add_u32 m0, s38, 19456
  s_nop 0
  buffer_load_dwordx4 v236, s[24:27], s32 offen nt lds
  s_waitcnt vmcnt(5)
  s_add_u32 s32, s46, 393216
  s_add_u32 m0, s38, 20480
  s_nop 0
  buffer_load_dwordx4 v236, s[24:27], s32 offen nt lds
  v_and_b32 v27, 8, v1
  v_xor_b32 v27, 8, v27
  v_mul_u32_u24 v27, 544, v27
  v_add_u32 v31, v31, v27
  s_mov_b32 s69, 524288
W_24:
  ds_read_b32 v26, v2 offset:5856
  s_waitcnt lgkmcnt(0)
  v_readfirstlane_b32 s30, v26
  s_nop 0
  s_cmp_ge_u32 s30, 4
  s_cbranch_scc1 WD_25
  s_sub_u32 s69, s69, 1
  s_cbranch_scc0 W_24
WD_25:
  ds_read_b128 v[192:195], v232 offset:0
  ds_read_b128 v[196:199], v232 offset:24576
  ds_read_b128 v[200:203], v233 offset:0
  ds_read_b128 v[204:207], v233 offset:24576
  s_waitcnt lgkmcnt(3)
  v_pk_mul_f32 v[208:209], v[192:193], v[228:229] op_sel:[0,0] op_sel_hi:[1,0]
  v_pk_mul_f32 v[210:211], v[194:195], v[228:229] op_sel:[0,0] op_sel_hi:[1,0]
  s_waitcnt lgkmcnt(2)
  v_pk_fma_f32 v[208:209], v[196:197], v[228:229], v[208:209] op_sel:[0,1,0] op_sel_hi:[1,1,1]
  v_pk_fma_f32 v[210:211], v[198:199], v[228:229], v[210:211] op_sel:[0,1,0] op_sel_hi:[1,1,1]
  s_waitcnt lgkmcnt(1)
  v_pk_fma_f32 v[208:209], v[200:201], v[230:231], v[208:209] op_sel:[0,0,0] op_sel_hi:[1,0,1]
  v_pk_fma_f32 v[210:211], v[202:203], v[230:231], v[210:211] op_sel:[0,0,0] op_sel_hi:[1,0,1]
  s_waitcnt lgkmcnt(0)
  v_pk_fma_f32 v[208:209], v[204:205], v[230:231], v[208:209] op_sel:[0,1,0] op_sel_hi:[1,1,1]
  v_pk_fma_f32 v[210:211], v[206:207], v[230:231], v[210:211] op_sel:[0,1,0] op_sel_hi:[1,1,1]
  s_waitcnt vmcnt(5)
  s_cmp_lg_u32 s3, 0
  s_cbranch_scc1 RK_26
  s_mov_b64 exec, 1
  v_add_u32 v72, 1, v72
  ds_write_b32 v2, v72 offset:5844
  s_mov_b64 exec, -1
RK_26:
  s_add_u32 s32, s46, 491520
  s_add_u32 m0, s38, 21504
  s_nop 0
  buffer_load_dwordx4 v236, s[24:27], s32 offen nt lds
  ds_read_b64_tr_b16 v[162:163], v16 offset:12288
  ds_read_b64_tr_b16 v[166:167], v17 offset:12288
  ds_read_b64_tr_b16 v[170:171], v18 offset:12288
  ds_read_b64_tr_b16 v[174:175], v19 offset:12288
  ds_read_b64_tr_b16 v[178:179], v20 offset:12288
  ds_read_b64_tr_b16 v[182:183], v21 offset:12288
  ds_read_b64_tr_b16 v[186:187], v22 offset:12288
  ds_read_b64_tr_b16 v[190:191], v23 offset:12288
  s_waitcnt lgkmcnt(7)
  v_mfma_f32_16x16x32_bf16 v[128:131], v[160:163], v[44:47], v[128:131]
  s_waitcnt lgkmcnt(6)
  v_mfma_f32_16x16x32_bf16 v[132:135], v[164:167], v[44:47], v[132:135]
  s_waitcnt lgkmcnt(5)
  v_mfma_f32_16x16x32_bf16 v[136:139], v[168:171], v[44:47], v[136:139]
  s_waitcnt lgkmcnt(4)
  v_mfma_f32_16x16x32_bf16 v[140:143], v[172:175], v[44:47], v[140:143]
  s_waitcnt lgkmcnt(3)
  v_mfma_f32_16x16x32_bf16 v[144:147], v[176:179], v[44:47], v[144:147]
  ds_write_b128 v31, v[128:131] offset:4352
  s_waitcnt lgkmcnt(3)
  v_mfma_f32_16x16x32_bf16 v[148:151], v[180:183], v[44:47], v[148:151]
  ds_write_b128 v31, v[132:135] offset:4416
  s_waitcnt lgkmcnt(3)
  v_mfma_f32_16x16x32_bf16 v[152:155], v[184:187], v[44:47], v[152:155]
  ds_write_b128 v31, v[136:139] offset:4480
  s_waitcnt lgkmcnt(3)
  v_mfma_f32_16x16x32_bf16 v[156:159], v[188:191], v[44:47], v[156:159]
  ds_write_b128 v31, v[140:143] offset:4544
  ds_write_b128 v31, v[144:147] offset:4608
  ds_write_b128 v31, v[148:151] offset:4672
  s_nop 1
  ds_write_b128 v31, v[152:155] offset:4736
  s_nop 1
  ds_write_b128 v31, v[156:159] offset:4800
  s_mov_b64 exec, 1
  ds_add_u32 v2, v3 offset:5784
  s_mov_b64 exec, -1
  s_mov_b32 s69, 524288
W_27:
  ds_read_b32 v26, v2 offset:5784
  s_waitcnt lgkmcnt(0)
  v_readfirstlane_b32 s30, v26
  s_nop 0
  s_cmp_ge_u32 s30, 4
  s_cbranch_scc1 WD_28
  s_sub_u32 s69, s69, 1
  s_cbranch_scc0 W_27
WD_28:
  ds_read_b128 v[192:195], v232 offset:4352
  ds_read_b128 v[196:199], v232 offset:28928
  ds_read_b128 v[200:203], v233 offset:4352
  ds_read_b128 v[204:207], v233 offset:28928
  s_waitcnt lgkmcnt(3)
  v_pk_fma_f32 v[208:209], v[192:193], v[228:229], v[208:209] op_sel:[0,0,0] op_sel_hi:[1,0,1]
  v_pk_fma_f32 v[210:211], v[194:195], v[228:229], v[210:211] op_sel:[0,0,0] op_sel_hi:[1,0,1]
  s_waitcnt lgkmcnt(2)
  v_pk_fma_f32 v[208:209], v[196:197], v[228:229], v[208:209] op_sel:[0,1,0] op_sel_hi:[1,1,1]
  v_pk_fma_f32 v[210:211], v[198:199], v[228:229], v[210:211] op_sel:[0,1,0] op_sel_hi:[1,1,1]
  s_waitcnt lgkmcnt(1)
  v_pk_fma_f32 v[208:209], v[200:201], v[230:231], v[208:209] op_sel:[0,0,0] op_sel_hi:[1,0,1]
  v_pk_fma_f32 v[210:211], v[202:203], v[230:231], v[210:211] op_sel:[0,0,0] op_sel_hi:[1,0,1]
  s_waitcnt lgkmcnt(0)
  v_pk_fma_f32 v[208:209], v[204:205], v[230:231], v[208:209] op_sel:[0,1,0] op_sel_hi:[1,1,1]
  v_pk_fma_f32 v[210:211], v[206:207], v[230:231], v[210:211] op_sel:[0,1,0] op_sel_hi:[1,1,1]
  v_and_or_b32 v208, v208, v247, s62
  v_and_or_b32 v211, v211, v247, s86
  buffer_store_dwordx4 v[208:211], v234, s[12:15], s45 offen sc1
  s_mov_b64 exec, 1
  ds_add_u32 v2, v3 offset:5808
  s_mov_b64 exec, -1
  s_waitcnt vmcnt(5)
  s_add_u32 s32, s46, 589824
  s_add_u32 m0, s38, 22528
  s_nop 0
  buffer_load_dwordx4 v236, s[24:27], s32 offen nt lds
  s_waitcnt vmcnt(5)
  s_add_u32 s32, s46, 688128
  s_add_u32 m0, s38, 23552
  s_nop 0
  buffer_load_dwordx4 v236, s[24:27], s32 offen nt lds
  ds_read2_b64 v[128:131], v30 offset0:0 offset1:4
  ds_read2_b64 v[132:135], v30 offset0:8 offset1:12
  ds_read2_b64 v[136:139], v30 offset0:16 offset1:20
  ds_read2_b64 v[140:143], v30 offset0:24 offset1:28
  ds_read2_b64 v[144:147], v30 offset0:32 offset1:36
  ds_read2_b64 v[148:151], v30 offset0:40 offset1:44
  ds_read2_b64 v[152:155], v30 offset0:48 offset1:52
  ds_read2_b64 v[156:159], v30 offset0:56 offset1:60
  s_mov_b32 s69, 524288
W_29:
  ds_read_b32 v6, v2 offset:5808
  s_waitcnt lgkmcnt(0)
  v_readfirstlane_b32 s30, v6
  s_nop 0
  s_cmp_ge_u32 s30, 4
  s_cbranch_scc1 WD_30
  s_sub_u32 s69, s69, 1
  s_cbranch_scc0 W_29
WD_30:
  s_mov_b32 s69, 524288
W_31:
  ds_read_b32 v4, v2 offset:5844
  s_waitcnt lgkmcnt(0)
  v_readfirstlane_b32 s30, v4
  s_nop 0
  s_cmp_ge_u32 s30, 1
  s_cbranch_scc1 WD_32
  s_sub_u32 s69, s69, 1
  s_cbranch_scc0 W_31
WD_32:
  s_sub_u32 s43, s30, 33
  s_cmp_ge_u32 s43, 64
  s_cbranch_scc1 E0_12
  s_lshl_b32 s30, s42, 2
  s_add_u32 s30, s30, s67
  s_mul_i32 s46, s30, 786432
  s_lshl_b32 s30, s43, 7
  s_add_u32 s46, s46, s30
  s_add_u32 s46, s46, 4096
  s_lshl_b32 s47, s42, 14
  s_lshl_b32 s30, s43, 8
  s_add_u32 s47, s47, s30
  s_lshl_b32 s30, s67, 6
  s_add_u32 s47, s47, s30
  s_add_u32 s47, s47, 196608
  s_waitcnt vmcnt(6)
  s_cmp_lg_u32 s3, 0
  s_cbranch_scc1 RK_33
  s_lshl_b32 s30, s42, 12
  s_add_u32 s30, s30, 393216
  v_mov_b32 v72, 1
  v_mov_b32 v73, 0
  s_mov_b64 exec, 1
  buffer_atomic_add v72, v73, s[12:15], s30 offen sc0 sc1
  s_mov_b64 exec, -1
RK_33:
  s_add_u32 s32, s46, 0
  s_add_u32 m0, s38, 8192
  s_nop 0
  buffer_load_dwordx4 v236, s[24:27], s32 offen nt lds
  s_waitcnt vmcnt(6)
  s_add_u32 s32, s46, 98304
  s_add_u32 m0, s38, 9216
  s_nop 0
  buffer_load_dwordx4 v236, s[24:27], s32 offen nt lds
  s_waitcnt vmcnt(6)
  s_add_u32 s32, s46, 196608
  s_add_u32 m0, s38, 10240
  s_nop 0
  buffer_load_dwordx4 v236, s[24:27], s32 offen nt lds
  s_waitcnt vmcnt(6)
  s_add_u32 s32, s46, 294912
  s_add_u32 m0, s38, 11264
  s_nop 0
  buffer_load_dwordx4 v236, s[24:27], s32 offen nt lds
  s_waitcnt vmcnt(6)
  s_add_u32 s32, s46, 393216
  s_add_u32 m0, s38, 12288
  s_nop 0
  buffer_load_dwordx4 v236, s[24:27], s32 offen nt lds
  s_waitcnt vmcnt(6)
  s_add_u32 s32, s46, 491520
  s_add_u32 m0, s38, 13312
  s_nop 0
  buffer_load_dwordx4 v236, s[24:27], s32 offen nt lds
  s_waitcnt vmcnt(6)
  s_cmp_lg_u32 s3, 0
  s_cbranch_scc1 RK_34
  s_mov_b64 exec, 1
  v_add_u32 v72, 1, v72
  ds_write_b32 v2, v72 offset:5848
  s_mov_b64 exec, -1
RK_34:
  s_add_u32 s32, s46, 589824
  s_add_u32 m0, s38, 14336
  s_nop 0
  buffer_load_dwordx4 v236, s[24:27], s32 offen nt lds
  s_waitcnt vmcnt(6)
  s_add_u32 s32, s46, 688128
  s_add_u32 m0, s38, 15360
  s_nop 0
  buffer_load_dwordx4 v236, s[24:27], s32 offen nt lds
  s_mov_b64 exec, 1
  ds_add_u32 v2, v3 offset:5776
  s_mov_b64 exec, -1
  s_mov_b32 s69, 524288
W_35:
  ds_read_b32 v6, v2 offset:5776
  s_waitcnt lgkmcnt(0)
  v_readfirstlane_b32 s30, v6
  s_nop 0
  s_cmp_ge_u32 s30, 4
  s_cbranch_scc1 WD_36
  s_sub_u32 s69, s69, 1
  s_cbranch_scc0 W_35
WD_36:
  ds_read_b64_tr_b16 v[96:97], v28 offset:16384
  ds_read_b64_tr_b16 v[98:99], v28 offset:18432
  ds_read_b64_tr_b16 v[100:101], v28 offset:20480
  ds_read_b64_tr_b16 v[102:103], v28 offset:22528
  ds_read_b64_tr_b16 v[104:105], v28 offset:40960
  ds_read_b64_tr_b16 v[106:107], v28 offset:43008
  ds_read_b64_tr_b16 v[108:109], v28 offset:45056
  ds_read_b64_tr_b16 v[110:111], v28 offset:47104
  ds_read_b64_tr_b16 v[112:113], v29 offset:16384
  ds_read_b64_tr_b16 v[114:115], v29 offset:18432
  ds_read_b64_tr_b16 v[116:117], v29 offset:20480
  ds_read_b64_tr_b16 v[118:119], v29 offset:22528
  ds_read_b64_tr_b16 v[120:121], v29 offset:40960
  ds_read_b64_tr_b16 v[122:123], v29 offset:43008
  ds_read_b64_tr_b16 v[124:125], v29 offset:45056
  ds_read_b64_tr_b16 v[126:127], v29 offset:47104
  s_waitcnt lgkmcnt(0)
  v_mfma_f32_16x16x32_bf16 v[8:11], v[96:99], v[128:131], 0
  v_mfma_f32_16x16x32_bf16 v[8:11], v[100:103], v[132:135], v[8:11]
  v_mfma_f32_16x16x32_bf16 v[8:11], v[104:107], v[136:139], v[8:11]
  v_mfma_f32_16x16x32_bf16 v[8:11], v[108:111], v[140:143], v[8:11]
  v_mfma_f32_16x16x32_bf16 v[8:11], v[112:115], v[144:147], v[8:11]
  v_mfma_f32_16x16x32_bf16 v[8:11], v[116:119], v[148:151], v[8:11]
  v_mfma_f32_16x16x32_bf16 v[8:11], v[120:123], v[152:155], v[8:11]
  v_mfma_f32_16x16x32_bf16 v[8:11], v[124:127], v[156:159], v[8:11]
  s_nop 7
  v_and_or_b32 v8, v8, v247, v243
  v_and_or_b32 v9, v9, v247, v243
  v_and_or_b32 v10, v10, v247, v243
  v_and_or_b32 v11, v11, v247, v243
  s_mov_b32 exec_lo, 0x10001
  s_mov_b32 exec_hi, 0x10001
  buffer_store_dwordx4 v[8:11], v242, s[12:15], s44 offen sc1
  s_mov_b64 exec, -1
  s_mov_b32 s69, 524288
W_37:
  ds_read_b32 v4, v2 offset:5848
  s_waitcnt lgkmcnt(0)
  v_readfirstlane_b32 s30, v4
  s_nop 0
  s_cmp_ge_u32 s30, 1
  s_cbranch_scc1 WD_38
  s_sub_u32 s69, s69, 1
  s_cbranch_scc0 W_37
WD_38:
  s_sub_u32 s43, s30, 33
  s_cmp_ge_u32 s43, 64
  s_cbranch_scc1 E1_13
  s_lshl_b32 s30, s42, 2
  s_add_u32 s30, s30, s67
  s_mul_i32 s46, s30, 786432
  s_lshl_b32 s30, s43, 7
  s_add_u32 s46, s46, s30
  s_add_u32 s46, s46, 4096
  s_lshl_b32 s58, s42, 14
  s_lshl_b32 s30, s43, 8
  s_add_u32 s58, s58, s30
  s_lshl_b32 s30, s67, 6
  s_add_u32 s58, s58, s30
  s_add_u32 s58, s58, 196608
  s_waitcnt vmcnt(6)
  s_add_u32 s32, s46, 0
  s_add_u32 m0, s38, 0
  s_nop 0
  buffer_load_dwordx4 v236, s[24:27], s32 offen nt lds
  s_waitcnt vmcnt(6)
  s_add_u32 s32, s46, 98304
  s_add_u32 m0, s38, 1024
  s_nop 0
  buffer_load_dwordx4 v236, s[24:27], s32 offen nt lds
  s_waitcnt vmcnt(6)
  s_add_u32 s32, s46, 196608
  s_add_u32 m0, s38, 2048
  s_nop 0
  buffer_load_dwordx4 v236, s[24:27], s32 offen nt lds
  s_waitcnt vmcnt(6)
  s_add_u32 s32, s46, 294912
  s_add_u32 m0, s38, 3072
  s_nop 0
  buffer_load_dwordx4 v236, s[24:27], s32 offen nt lds
  s_waitcnt vmcnt(6)
  s_add_u32 s32, s46, 393216
  s_add_u32 m0, s38, 4096
  s_nop 0
  buffer_load_dwordx4 v236, s[24:27], s32 offen nt lds
  s_waitcnt vmcnt(6)
  s_add_u32 s32, s46, 491520
  s_add_u32 m0, s38, 5120
  s_nop 0
  buffer_load_dwordx4 v236, s[24:27], s32 offen nt lds
  s_waitcnt vmcnt(6)
  s_add_u32 s32, s46, 589824
  s_add_u32 m0, s38, 6144
  s_nop 0
  buffer_load_dwordx4 v236, s[24:27], s32 offen nt lds
  s_waitcnt vmcnt(6)
  s_add_u32 s32, s46, 688128
  s_add_u32 m0, s38, 7168
  s_nop 0
  buffer_load_dwordx4 v236, s[24:27], s32 offen nt lds
  s_mov_b64 exec, 1
  ds_add_u32 v2, v3 offset:5776
  s_mov_b64 exec, -1
  s_mov_b32 s69, 524288
W_39:
  ds_read_b32 v6, v2 offset:5776
  s_waitcnt lgkmcnt(0)
  v_readfirstlane_b32 s30, v6
  s_nop 0
  s_cmp_ge_u32 s30, 8
  s_cbranch_scc1 WD_40
  s_sub_u32 s69, s69, 1
  s_cbranch_scc0 W_39
WD_40:
  ds_read_b64_tr_b16 v[96:97], v28 offset:8192
  ds_read_b64_tr_b16 v[98:99], v28 offset:10240
  ds_read_b64_tr_b16 v[100:101], v28 offset:12288
  ds_read_b64_tr_b16 v[102:103], v28 offset:14336
  ds_read_b64_tr_b16 v[104:105], v28 offset:32768
  ds_read_b64_tr_b16 v[106:107], v28 offset:34816
  ds_read_b64_tr_b16 v[108:109], v28 offset:36864
  ds_read_b64_tr_b16 v[110:111], v28 offset:38912
  ds_read_b64_tr_b16 v[112:113], v29 offset:8192
  ds_read_b64_tr_b16 v[114:115], v29 offset:10240
  ds_read_b64_tr_b16 v[116:117], v29 offset:12288
  ds_read_b64_tr_b16 v[118:119], v29 offset:14336
  ds_read_b64_tr_b16 v[120:121], v29 offset:32768
  ds_read_b64_tr_b16 v[122:123], v29 offset:34816
  ds_read_b64_tr_b16 v[124:125], v29 offset:36864
  ds_read_b64_tr_b16 v[126:127], v29 offset:38912
  s_waitcnt lgkmcnt(0)
  v_mfma_f32_16x16x32_bf16 v[12:15], v[96:99], v[128:131], 0
  v_mfma_f32_16x16x32_bf16 v[12:15], v[100:103], v[132:135], v[12:15]
  v_mfma_f32_16x16x32_bf16 v[12:15], v[104:107], v[136:139], v[12:15]
  v_mfma_f32_16x16x32_bf16 v[12:15], v[108:111], v[140:143], v[12:15]
  v_mfma_f32_16x16x32_bf16 v[12:15], v[112:115], v[144:147], v[12:15]
  v_mfma_f32_16x16x32_bf16 v[12:15], v[116:119], v[148:151], v[12:15]
  v_mfma_f32_16x16x32_bf16 v[12:15], v[120:123], v[152:155], v[12:15]
  v_mfma_f32_16x16x32_bf16 v[12:15], v[124:127], v[156:159], v[12:15]
  s_nop 7
  v_and_or_b32 v12, v12, v247, v243
  v_and_or_b32 v13, v13, v247, v243
  v_and_or_b32 v14, v14, v247, v243
  v_and_or_b32 v15, v15, v247, v243
  s_mov_b32 exec_lo, 0x10001
  s_mov_b32 exec_hi, 0x10001
  buffer_store_dwordx4 v[12:15], v242, s[12:15], s47 offen sc1
  s_mov_b64 exec, -1
  s_waitcnt vmcnt(1)
  s_mov_b64 exec, 1
  ds_add_u32 v2, v3 offset:5776
  s_mov_b64 exec, -1
  s_mov_b32 s69, 524288
W_41:
  ds_read_b32 v6, v2 offset:5776
  s_waitcnt lgkmcnt(0)
  v_readfirstlane_b32 s30, v6
  s_nop 0
  s_cmp_ge_u32 s30, 12
  s_cbranch_scc1 WD_42
  s_sub_u32 s69, s69, 1
  s_cbranch_scc0 W_41
WD_42:
  ds_read_b64_tr_b16 v[96:97], v28 offset:0
  ds_read_b64_tr_b16 v[98:99], v28 offset:2048
  ds_read_b64_tr_b16 v[100:101], v28 offset:4096
  ds_read_b64_tr_b16 v[102:103], v28 offset:6144
  ds_read_b64_tr_b16 v[104:105], v28 offset:24576
  ds_read_b64_tr_b16 v[106:107], v28 offset:26624
  ds_read_b64_tr_b16 v[108:109], v28 offset:28672
  ds_read_b64_tr_b16 v[110:111], v28 offset:30720
  ds_read_b64_tr_b16 v[112:113], v29 offset:0
  ds_read_b64_tr_b16 v[114:115], v29 offset:2048
  ds_read_b64_tr_b16 v[116:117], v29 offset:4096
  ds_read_b64_tr_b16 v[118:119], v29 offset:6144
  ds_read_b64_tr_b16 v[120:121], v29 offset:24576
  ds_read_b64_tr_b16 v[122:123], v29 offset:26624
  ds_read_b64_tr_b16 v[124:125], v29 offset:28672
  ds_read_b64_tr_b16 v[126:127], v29 offset:30720
  s_waitcnt lgkmcnt(0)
  v_mfma_f32_16x16x32_bf16 v[16:19], v[96:99], v[128:131], 0
  v_mfma_f32_16x16x32_bf16 v[16:19], v[100:103], v[132:135], v[16:19]
  v_mfma_f32_16x16x32_bf16 v[16:19], v[104:107], v[136:139], v[16:19]
  v_mfma_f32_16x16x32_bf16 v[16:19], v[108:111], v[140:143], v[16:19]
  v_mfma_f32_16x16x32_bf16 v[16:19], v[112:115], v[144:147], v[16:19]
  v_mfma_f32_16x16x32_bf16 v[16:19], v[116:119], v[148:151], v[16:19]
  v_mfma_f32_16x16x32_bf16 v[16:19], v[120:123], v[152:155], v[16:19]
  v_mfma_f32_16x16x32_bf16 v[16:19], v[124:127], v[156:159], v[16:19]
  s_nop 7
  v_and_or_b32 v16, v16, v247, v243
  v_and_or_b32 v17, v17, v247, v243
  v_and_or_b32 v18, v18, v247, v243
  v_and_or_b32 v19, v19, v247, v243
  s_mov_b32 exec_lo, 0x10001
  s_mov_b32 exec_hi, 0x10001
  buffer_store_dwordx4 v[16:19], v242, s[12:15], s58 offen sc1
  s_mov_b64 exec, -1
  s_branch TD_14
E1_13:
  s_waitcnt vmcnt(1)
  s_mov_b64 exec, 1
  ds_add_u32 v2, v3 offset:5776
  s_mov_b64 exec, -1
  s_mov_b32 s69, 524288
W_43:
  ds_read_b32 v6, v2 offset:5776
  s_waitcnt lgkmcnt(0)
  v_readfirstlane_b32 s30, v6
  s_nop 0
  s_cmp_ge_u32 s30, 8
  s_cbranch_scc1 WD_44
  s_sub_u32 s69, s69, 1
  s_cbranch_scc0 W_43
WD_44:
  ds_read_b64_tr_b16 v[96:97], v28 offset:8192
  ds_read_b64_tr_b16 v[98:99], v28 offset:10240
  ds_read_b64_tr_b16 v[100:101], v28 offset:12288
  ds_read_b64_tr_b16 v[102:103], v28 offset:14336
  ds_read_b64_tr_b16 v[104:105], v28 offset:32768
  ds_read_b64_tr_b16 v[106:107], v28 offset:34816
  ds_read_b64_tr_b16 v[108:109], v28 offset:36864
  ds_read_b64_tr_b16 v[110:111], v28 offset:38912
  ds_read_b64_tr_b16 v[112:113], v29 offset:8192
  ds_read_b64_tr_b16 v[114:115], v29 offset:10240
  ds_read_b64_tr_b16 v[116:117], v29 offset:12288
  ds_read_b64_tr_b16 v[118:119], v29 offset:14336
  ds_read_b64_tr_b16 v[120:121], v29 offset:32768
  ds_read_b64_tr_b16 v[122:123], v29 offset:34816
  ds_read_b64_tr_b16 v[124:125], v29 offset:36864
  ds_read_b64_tr_b16 v[126:127], v29 offset:38912
  s_waitcnt lgkmcnt(0)
  v_mfma_f32_16x16x32_bf16 v[12:15], v[96:99], v[128:131], 0
  v_mfma_f32_16x16x32_bf16 v[12:15], v[100:103], v[132:135], v[12:15]
  v_mfma_f32_16x16x32_bf16 v[12:15], v[104:107], v[136:139], v[12:15]
  v_mfma_f32_16x16x32_bf16 v[12:15], v[108:111], v[140:143], v[12:15]
  v_mfma_f32_16x16x32_bf16 v[12:15], v[112:115], v[144:147], v[12:15]
  v_mfma_f32_16x16x32_bf16 v[12:15], v[116:119], v[148:151], v[12:15]
  v_mfma_f32_16x16x32_bf16 v[12:15], v[120:123], v[152:155], v[12:15]
  v_mfma_f32_16x16x32_bf16 v[12:15], v[124:127], v[156:159], v[12:15]
  s_nop 7
  v_and_or_b32 v12, v12, v247, v243
  v_and_or_b32 v13, v13, v247, v243
  v_and_or_b32 v14, v14, v247, v243
  v_and_or_b32 v15, v15, v247, v243
  s_mov_b32 exec_lo, 0x10001
  s_mov_b32 exec_hi, 0x10001
  buffer_store_dwordx4 v[12:15], v242, s[12:15], s47 offen sc1
  s_mov_b64 exec, -1
  s_branch TD_14
E0_12:
  s_waitcnt vmcnt(0)
  s_mov_b64 exec, 1
  ds_add_u32 v2, v3 offset:5776
  s_mov_b64 exec, -1
  s_mov_b32 s69, 524288
W_45:
  ds_read_b32 v6, v2 offset:5776
  s_waitcnt lgkmcnt(0)
  v_readfirstlane_b32 s30, v6
  s_nop 0
  s_cmp_ge_u32 s30, 4
  s_cbranch_scc1 WD_46
  s_sub_u32 s69, s69, 1
  s_cbranch_scc0 W_45
WD_46:
  ds_read_b64_tr_b16 v[96:97], v28 offset:16384
  ds_read_b64_tr_b16 v[98:99], v28 offset:18432
  ds_read_b64_tr_b16 v[100:101], v28 offset:20480
  ds_read_b64_tr_b16 v[102:103], v28 offset:22528
  ds_read_b64_tr_b16 v[104:105], v28 offset:40960
  ds_read_b64_tr_b16 v[106:107], v28 offset:43008
  ds_read_b64_tr_b16 v[108:109], v28 offset:45056
  ds_read_b64_tr_b16 v[110:111], v28 offset:47104
  ds_read_b64_tr_b16 v[112:113], v29 offset:16384
  ds_read_b64_tr_b16 v[114:115], v29 offset:18432
  ds_read_b64_tr_b16 v[116:117], v29 offset:20480
  ds_read_b64_tr_b16 v[118:119], v29 offset:22528
  ds_read_b64_tr_b16 v[120:121], v29 offset:40960
  ds_read_b64_tr_b16 v[122:123], v29 offset:43008
  ds_read_b64_tr_b16 v[124:125], v29 offset:45056
  ds_read_b64_tr_b16 v[126:127], v29 offset:47104
  s_waitcnt lgkmcnt(0)
  v_mfma_f32_16x16x32_bf16 v[8:11], v[96:99], v[128:131], 0
  v_mfma_f32_16x16x32_bf16 v[8:11], v[100:103], v[132:135], v[8:11]
  v_mfma_f32_16x16x32_bf16 v[8:11], v[104:107], v[136:139], v[8:11]
  v_mfma_f32_16x16x32_bf16 v[8:11], v[108:111], v[140:143], v[8:11]
  v_mfma_f32_16x16x32_bf16 v[8:11], v[112:115], v[144:147], v[8:11]
  v_mfma_f32_16x16x32_bf16 v[8:11], v[116:119], v[148:151], v[8:11]
  v_mfma_f32_16x16x32_bf16 v[8:11], v[120:123], v[152:155], v[8:11]
  v_mfma_f32_16x16x32_bf16 v[8:11], v[124:127], v[156:159], v[8:11]
  s_nop 7
  v_and_or_b32 v8, v8, v247, v243
  v_and_or_b32 v9, v9, v247, v243
  v_and_or_b32 v10, v10, v247, v243
  v_and_or_b32 v11, v11, v247, v243
  s_mov_b32 exec_lo, 0x10001
  s_mov_b32 exec_hi, 0x10001
  buffer_store_dwordx4 v[8:11], v242, s[12:15], s44 offen sc1
  s_mov_b64 exec, -1
  s_branch TD_14
N_11:
  s_waitcnt vmcnt(4)
  ds_read_b64_tr_b16 v[160:161], v16 offset:8192
  ds_read_b64_tr_b16 v[164:165], v17 offset:8192
  ds_read_b64_tr_b16 v[168:169], v18 offset:8192
  ds_read_b64_tr_b16 v[172:173], v19 offset:8192
  ds_read_b64_tr_b16 v[176:177], v20 offset:8192
  ds_read_b64_tr_b16 v[180:181], v21 offset:8192
  ds_read_b64_tr_b16 v[184:185], v22 offset:8192
  ds_read_b64_tr_b16 v[188:189], v23 offset:8192
  s_waitcnt vmcnt(1)
  v_and_b32 v27, 8, v1
  v_xor_b32 v27, 8, v27
  v_mul_u32_u24 v27, 544, v27
  v_add_u32 v31, v31, v27
  s_mov_b32 s69, 524288
W_47:
  ds_read_b32 v26, v2 offset:5856
  s_waitcnt lgkmcnt(0)
  v_readfirstlane_b32 s30, v26
  s_nop 0
  s_cmp_ge_u32 s30, 4
  s_cbranch_scc1 WD_48
  s_sub_u32 s69, s69, 1
  s_cbranch_scc0 W_47
WD_48:
  ds_read_b128 v[192:195], v232 offset:0
  ds_read_b128 v[196:199], v232 offset:24576
  ds_read_b128 v[200:203], v233 offset:0
  ds_read_b128 v[204:207], v233 offset:24576
  s_waitcnt lgkmcnt(3)
  v_pk_mul_f32 v[208:209], v[192:193], v[228:229] op_sel:[0,0] op_sel_hi:[1,0]
  v_pk_mul_f32 v[210:211], v[194:195], v[228:229] op_sel:[0,0] op_sel_hi:[1,0]
  s_waitcnt lgkmcnt(2)
  v_pk_fma_f32 v[208:209], v[196:197], v[228:229], v[208:209] op_sel:[0,1,0] op_sel_hi:[1,1,1]
  v_pk_fma_f32 v[210:211], v[198:199], v[228:229], v[210:211] op_sel:[0,1,0] op_sel_hi:[1,1,1]
  s_waitcnt lgkmcnt(1)
  v_pk_fma_f32 v[208:209], v[200:201], v[230:231], v[208:209] op_sel:[0,0,0] op_sel_hi:[1,0,1]
  v_pk_fma_f32 v[210:211], v[202:203], v[230:231], v[210:211] op_sel:[0,0,0] op_sel_hi:[1,0,1]
  s_waitcnt lgkmcnt(0)
  v_pk_fma_f32 v[208:209], v[204:205], v[230:231], v[208:209] op_sel:[0,1,0] op_sel_hi:[1,1,1]
  v_pk_fma_f32 v[210:211], v[206:207], v[230:231], v[210:211] op_sel:[0,1,0] op_sel_hi:[1,1,1]
  s_waitcnt vmcnt(0)
  ds_read_b64_tr_b16 v[162:163], v16 offset:12288
  ds_read_b64_tr_b16 v[166:167], v17 offset:12288
  ds_read_b64_tr_b16 v[170:171], v18 offset:12288
  ds_read_b64_tr_b16 v[174:175], v19 offset:12288
  ds_read_b64_tr_b16 v[178:179], v20 offset:12288
  ds_read_b64_tr_b16 v[182:183], v21 offset:12288
  ds_read_b64_tr_b16 v[186:187], v22 offset:12288
  ds_read_b64_tr_b16 v[190:191], v23 offset:12288
  s_waitcnt lgkmcnt(7)
  v_mfma_f32_16x16x32_bf16 v[128:131], v[160:163], v[44:47], v[128:131]
  s_waitcnt lgkmcnt(6)
  v_mfma_f32_16x16x32_bf16 v[132:135], v[164:167], v[44:47], v[132:135]
  s_waitcnt lgkmcnt(5)
  v_mfma_f32_16x16x32_bf16 v[136:139], v[168:171], v[44:47], v[136:139]
  s_waitcnt lgkmcnt(4)
  v_mfma_f32_16x16x32_bf16 v[140:143], v[172:175], v[44:47], v[140:143]
  s_waitcnt lgkmcnt(3)
  v_mfma_f32_16x16x32_bf16 v[144:147], v[176:179], v[44:47], v[144:147]
  ds_write_b128 v31, v[128:131] offset:4352
  s_waitcnt lgkmcnt(3)
  v_mfma_f32_16x16x32_bf16 v[148:151], v[180:183], v[44:47], v[148:151]
  ds_write_b128 v31, v[132:135] offset:4416
  s_waitcnt lgkmcnt(3)
  v_mfma_f32_16x16x32_bf16 v[152:155], v[184:187], v[44:47], v[152:155]
  ds_write_b128 v31, v[136:139] offset:4480
  s_waitcnt lgkmcnt(3)
  v_mfma_f32_16x16x32_bf16 v[156:159], v[188:191], v[44:47], v[156:159]
  ds_write_b128 v31, v[140:143] offset:4544
  ds_write_b128 v31, v[144:147] offset:4608
  ds_write_b128 v31, v[148:151] offset:4672
  s_nop 1
  ds_write_b128 v31, v[152:155] offset:4736
  s_nop 1
  ds_write_b128 v31, v[156:159] offset:4800
  s_mov_b64 exec, 1
  ds_add_u32 v2, v3 offset:5784
  s_mov_b64 exec, -1
  s_mov_b32 s69, 524288
W_49:
  ds_read_b32 v26, v2 offset:5784
  s_waitcnt lgkmcnt(0)
  v_readfirstlane_b32 s30, v26
  s_nop 0
  s_cmp_ge_u32 s30, 4
  s_cbranch_scc1 WD_50
  s_sub_u32 s69, s69, 1
  s_cbranch_scc0 W_49
WD_50:
  ds_read_b128 v[192:195], v232 offset:4352
  ds_read_b128 v[196:199], v232 offset:28928
  ds_read_b128 v[200:203], v233 offset:4352
  ds_read_b128 v[204:207], v233 offset:28928
  s_waitcnt lgkmcnt(3)
  v_pk_fma_f32 v[208:209], v[192:193], v[228:229], v[208:209] op_sel:[0,0,0] op_sel_hi:[1,0,1]
  v_pk_fma_f32 v[210:211], v[194:195], v[228:229], v[210:211] op_sel:[0,0,0] op_sel_hi:[1,0,1]
  s_waitcnt lgkmcnt(2)
  v_pk_fma_f32 v[208:209], v[196:197], v[228:229], v[208:209] op_sel:[0,1,0] op_sel_hi:[1,1,1]
  v_pk_fma_f32 v[210:211], v[198:199], v[228:229], v[210:211] op_sel:[0,1,0] op_sel_hi:[1,1,1]
  s_waitcnt lgkmcnt(1)
  v_pk_fma_f32 v[208:209], v[200:201], v[230:231], v[208:209] op_sel:[0,0,0] op_sel_hi:[1,0,1]
  v_pk_fma_f32 v[210:211], v[202:203], v[230:231], v[210:211] op_sel:[0,0,0] op_sel_hi:[1,0,1]
  s_waitcnt lgkmcnt(0)
  v_pk_fma_f32 v[208:209], v[204:205], v[230:231], v[208:209] op_sel:[0,1,0] op_sel_hi:[1,1,1]
  v_pk_fma_f32 v[210:211], v[206:207], v[230:231], v[210:211] op_sel:[0,1,0] op_sel_hi:[1,1,1]
  v_and_or_b32 v208, v208, v247, s62
  v_and_or_b32 v211, v211, v247, s86
  buffer_store_dwordx4 v[208:211], v234, s[12:15], s45 offen sc1
  s_mov_b64 exec, 1
  ds_add_u32 v2, v3 offset:5808
  s_mov_b64 exec, -1
TD_14:
  s_mov_b64 exec, 1
  ds_add_u32 v2, v3 offset:5852
  s_mov_b64 exec, -1
  s_and_b32 s30, s2, 7
  s_cmp_lg_u32 s30, 0
  s_cbranch_scc1 L_fin2
  s_cmp_lg_u32 s3, 2
  s_cbranch_scc1 GB_51
  v_lshrrev_b32 v9, 4, v1
  v_and_b32 v13, 7, v1
  v_lshl_add_u32 v30, v13, 2, v9
  v_lshl_add_u32 v30, s91, 2, v30
  v_lshlrev_b32 v29, 1, v30
  v_lshlrev_b32 v30, 2, v30
  v_lshrrev_b32 v11, 3, v1
  v_and_b32 v11, 1, v11
  v_cmp_eq_u32 s[100:101], 1, v11
  v_lshl_add_u32 v28, v11, 15, v30
  v_lshlrev_b32 v31, 4, v11
  v_lshl_add_u32 v31, v9, 2, v31
  v_lshl_add_u32 v31, s91, 2, v31
  v_lshlrev_b32 v5, 4, v1
  v_lshl_add_u32 v6, v1, 4, v2
  v_add_u32 v150, 1, v1
  v_and_b32 v150, 3, v150
  v_xor_b32 v150, s86, v150
  v_mov_b32 v151, s66
  v_and_b32 v158, 3, v151
  v_cmp_eq_u32 vcc, 3, v9
  s_nop 1
  v_cndmask_b32 v158, v158, v151, vcc
  s_mov_b32 s92, 0x33000
  s_mov_b32 s93, 0x37000
  buffer_load_dword v108, v28, s[12:15], s92 offen offset:0 sc1
  buffer_load_dword v109, v28, s[12:15], s93 offen offset:0 sc1
  s_mov_b32 s69, 524288
G_52:
  s_waitcnt vmcnt(1)
  v_and_b32 v26, 0xff, v108
  v_cmp_ne_u32 s[70:71], v150, v26
  s_waitcnt vmcnt(0)
  v_and_b32 v26, 0xff, v109
  v_cmp_ne_u32 s[72:73], v150, v26
  s_nop 0
  s_or_b64 s[28:29], s[70:71], s[72:73]
  s_cbranch_scc0 GD_53
GT_54:
  s_sub_u32 s69, s69, 1
  s_cbranch_scc1 GX_55
  s_sleep 2
  s_wqm_b64 exec, s[70:71]
  s_cbranch_execz GS_56
  buffer_load_dword v108, v28, s[12:15], s92 offen offset:0 sc1
GS_56:
  s_wqm_b64 exec, s[72:73]
  s_cbranch_execz GS_57
  buffer_load_dword v109, v28, s[12:15], s93 offen offset:0 sc1
GS_57:
  s_mov_b64 exec, -1
  s_waitcnt vmcnt(0)
  s_branch G_52
GD_53:
GX_55:
  v_and_b32 v108, v247, v108
  v_and_b32 v109, v247, v109
  v_add_f32 v155, v108, v109
  s_nop 1
  v_add_f32_dpp v155, v155, v155 row_ror:8 row_mask:0xf bank_mask:0xf
  v_cvt_pk_bf16_f32 v155, 0, v155
  ds_write_b32 v6, v155 offset:7808
  s_mov_b64 exec, 1
  ds_add_u32 v2, v3 offset:5864
  s_mov_b64 exec, -1
  s_branch L_fin2
GB_51:
  s_cmp_lg_u32 s3, 1
  s_cbranch_scc1 L_fin2
  v_lshrrev_b32 v9, 4, v1
  v_and_b32 v13, 7, v1
  v_lshl_add_u32 v30, v13, 2, v9
  v_lshl_add_u32 v30, s91, 2, v30
  v_lshlrev_b32 v29, 1, v30
  v_lshlrev_b32 v30, 2, v30
  v_lshrrev_b32 v11, 3, v1
  v_and_b32 v11, 1, v11
  v_cmp_eq_u32 s[100:101], 1, v11
  v_lshl_add_u32 v28, v11, 15, v30
  v_lshlrev_b32 v31, 4, v11
  v_lshl_add_u32 v31, v9, 2, v31
  v_lshl_add_u32 v31, s91, 2, v31
  v_lshlrev_b32 v5, 4, v1
  v_lshl_add_u32 v6, v1, 4, v2
  v_add_u32 v150, 1, v1
  v_and_b32 v150, 3, v150
  v_xor_b32 v150, s86, v150
  v_mov_b32 v151, s66
  v_and_b32 v158, 3, v151
  v_cmp_eq_u32 vcc, 3, v9
  s_nop 1
  v_cndmask_b32 v158, v158, v151, vcc
  s_mov_b32 s69, 524288
W_58:
  ds_read_b32 v12, v2 offset:5868
  s_waitcnt lgkmcnt(0)
  v_readfirstlane_b32 s30, v12
  s_nop 0
  s_cmp_ge_u32 s30, 1
  s_cbranch_scc1 WD_59
  s_sleep 1
  s_sub_u32 s69, s69, 1
  s_cbranch_scc0 W_58
WD_59:
  s_cmp_eq_u32 s30, 1
  s_cselect_b32 s44, 0, 4096
  s_mov_b32 s40, 327680
  s_mov_b32 s41, 335872
  s_lshl_b32 s42, s91, 7
  s_add_u32 s42, s42, 425984
  buffer_load_dword v120, v5, s[12:15], s40 offen sc1
  buffer_load_dword v121, v5, s[12:15], s41 offen sc1
  buffer_load_dword v122, v5, s[12:15], s42 offen sc1
  s_mov_b32 s92, 0x30000
  s_mov_b32 s93, 0x34000
  s_mov_b32 s94, 0x31000
  s_mov_b32 s95, 0x35000
  s_mov_b32 s96, 0x32000
  s_mov_b32 s97, 0x36000
  buffer_load_dword v100, v28, s[12:15], s92 offen offset:0 sc1
  buffer_load_dword v101, v28, s[12:15], s93 offen offset:0 sc1
  buffer_load_dword v102, v28, s[12:15], s94 offen offset:0 sc1
  buffer_load_dword v103, v28, s[12:15], s95 offen offset:0 sc1
  buffer_load_dword v104, v28, s[12:15], s96 offen offset:0 sc1
  buffer_load_dword v105, v28, s[12:15], s97 offen offset:0 sc1
  s_mov_b32 s69, 524288
G_60:
  s_waitcnt vmcnt(5)
  v_and_b32 v26, 0xff, v100
  v_cmp_ne_u32 s[70:71], v150, v26
  s_waitcnt vmcnt(4)
  v_and_b32 v26, 0xff, v101
  v_cmp_ne_u32 s[72:73], v150, v26
  s_waitcnt vmcnt(3)
  v_and_b32 v26, 0xff, v102
  v_cmp_ne_u32 s[74:75], v150, v26
  s_waitcnt vmcnt(2)
  v_and_b32 v26, 0xff, v103
  v_cmp_ne_u32 s[76:77], v150, v26
  s_waitcnt vmcnt(1)
  v_and_b32 v26, 0xff, v104
  v_cmp_ne_u32 s[78:79], v150, v26
  s_waitcnt vmcnt(0)
  v_and_b32 v26, 0xff, v105
  v_cmp_ne_u32 s[80:81], v150, v26
  s_or_b64 s[28:29], s[70:71], s[72:73]
  s_or_b64 s[28:29], s[28:29], s[74:75]
  s_or_b64 s[28:29], s[28:29], s[76:77]
  s_or_b64 s[28:29], s[28:29], s[78:79]
  s_or_b64 s[28:29], s[28:29], s[80:81]
  s_cbranch_scc0 GD_61
GT_62:
  s_sub_u32 s69, s69, 1
  s_cbranch_scc1 GX_63
  s_sleep 2
  s_wqm_b64 exec, s[70:71]
  s_cbranch_execz GS_64
  buffer_load_dword v100, v28, s[12:15], s92 offen offset:0 sc1
GS_64:
  s_wqm_b64 exec, s[72:73]
  s_cbranch_execz GS_65
  buffer_load_dword v101, v28, s[12:15], s93 offen offset:0 sc1
GS_65:
  s_wqm_b64 exec, s[74:75]
  s_cbranch_execz GS_66
  buffer_load_dword v102, v28, s[12:15], s94 offen offset:0 sc1
GS_66:
  s_wqm_b64 exec, s[76:77]
  s_cbranch_execz GS_67
  buffer_load_dword v103, v28, s[12:15], s95 offen offset:0 sc1
GS_67:
  s_wqm_b64 exec, s[78:79]
  s_cbranch_execz GS_68
  buffer_load_dword v104, v28, s[12:15], s96 offen offset:0 sc1
GS_68:
  s_wqm_b64 exec, s[80:81]
  s_cbranch_execz GS_69
  buffer_load_dword v105, v28, s[12:15], s97 offen offset:0 sc1
GS_69:
  s_mov_b64 exec, -1
  s_waitcnt vmcnt(0)
  s_branch G_60
GD_61:
GX_63:
  v_and_b32 v100, v247, v100
  v_and_b32 v101, v247, v101
  v_and_b32 v102, v247, v102
  v_and_b32 v103, v247, v103
  v_and_b32 v104, v247, v104
  v_and_b32 v105, v247, v105
  v_add_f32 v152, v100, v101
  v_add_f32 v153, v102, v103
  v_add_f32 v154, v104, v105
  v_add_f32_dpp v152, v152, v152 row_ror:8 row_mask:0xf bank_mask:0xf
  v_add_f32_dpp v153, v153, v153 row_ror:8 row_mask:0xf bank_mask:0xf
  v_add_f32_dpp v154, v154, v154 row_ror:8 row_mask:0xf bank_mask:0xf
  v_cvt_pk_bf16_f32 v152, 0, v152
  v_cvt_pk_bf16_f32 v153, 0, v153
  v_cvt_pk_bf16_f32 v154, 0, v154
  v_add_f32 v154, 1.0, v154
  v_cvt_pk_bf16_f32 v154, 0, v154
  ds_write_b128 v6, v[152:155] offset:6656
  s_mov_b64 exec, 1
  ds_add_u32 v2, v3 offset:5840
  s_mov_b64 exec, -1
  v_cndmask_b32 v157, v154, v153, s[100:101]
  v_cndmask_b32 v16, 1.0, v153, s[100:101]
  v_mul_f32 v20, v157, v16
  v_mul_f32 v21, v157, v154
  v_cndmask_b32 v22, v153, 0, s[100:101]
  v_mov_b32 v23, 0
  s_mov_b32 s41, 327680
  v_permlane32_swap_b32 v20, v22
  v_permlane32_swap_b32 v21, v23
  v_pk_add_f32 v[20:21], v[20:21], v[22:23]
  s_nop 1
  v_permlane16_swap_b32 v20, v21
  v_add_f32 v20, v20, v21
  s_nop 1
  v_add_f32_dpp v20, v20, v20 quad_perm:[1,0,3,2] row_mask:0xf bank_mask:0xf
  s_nop 1
  v_add_f32_dpp v20, v20, v20 quad_perm:[2,3,0,1] row_mask:0xf bank_mask:0xf
  s_nop 1
  v_add_f32_dpp v20, v20, v20 row_half_mirror row_mask:0xf bank_mask:0xf
  v_and_or_b32 v20, v20, -4, v158
  s_mov_b32 exec_lo, 0x1010101
  s_mov_b32 exec_hi, 0x1010101
  s_cmp_lg_u32 s44, 0
  s_cbranch_scc1 SB_70
  buffer_store_dword v20, v31, s[12:15], s41 offen
SE_71:
  s_mov_b64 exec, -1
  s_add_u32 s92, s44, 0x50000
  buffer_load_dwordx4 v[104:107], v5, s[12:15], s92 offen sc1
  s_mov_b32 s69, 524288
G_72:
  s_waitcnt vmcnt(0)
  v_bitop3_b32 v26, v104, v105, v107 bitop3:0x7e
  v_xor_b32 v27, v106, v107
  v_xor_b32 v25, s66, v107
  v_or_b32 v26, v26, v27
  v_and_or_b32 v26, v26, 3, v25
  v_cmp_ne_u32 vcc, 0, v26
  s_cbranch_vccz GD_73
  s_sleep 1
  s_mov_b64 exec, vcc
  buffer_load_dwordx4 v[104:107], v5, s[12:15], s92 offen sc1
  s_mov_b64 exec, -1
  s_sub_u32 s69, s69, 1
  s_cbranch_scc0 G_72
  s_waitcnt vmcnt(0)
GD_73:
  v_and_b32 v104, -4, v104
  v_and_b32 v105, -4, v105
  v_and_b32 v106, -4, v106
  s_nop 1
  v_permlane32_swap_b32 v104, v106
  v_permlane32_swap_b32 v105, v107
  v_pk_add_f32 v[104:105], v[104:105], v[106:107]
  s_nop 1
  v_permlane16_swap_b32 v104, v105
  v_add_f32 v104, v104, v105
  s_nop 1
  v_add_f32_dpp v104, v104, v104 quad_perm:[2,3,0,1] row_mask:0xf bank_mask:0xf
  s_nop 1
  v_add_f32_dpp v104, v104, v104 row_ror:4 row_mask:0xf bank_mask:0xf
  s_nop 1
  v_add_f32_dpp v104, v104, v104 row_ror:8 row_mask:0xf bank_mask:0xf
  v_and_b32 v13, 1, v1
  v_lshlrev_b32 v13, 4, v13
  v_lshl_add_u32 v13, v9, 2, v13
  v_add_u32 v13, v2, v13
  s_mov_b32 exec_lo, 0x30003
  s_mov_b32 exec_hi, 0x30003
  ds_write_b32 v13, v104 offset:7680
  s_mov_b64 exec, 1
  ds_add_u32 v2, v3 offset:5828
  s_mov_b64 exec, -1
  s_branch L_fin2
L_X:
  s_setprio 3
  v_and_b32 v10, 255, v0
  v_lshlrev_b32 v11, 3, v10
  global_load_dwordx2 v[12:13], v11, s[56:57]
  v_lshlrev_b32 v11, 5, v1
  global_load_dwordx4 v[16:19], v11, s[36:37]
  global_load_dwordx4 v[20:23], v11, s[36:37] offset:16
  s_and_b32 s42, s2, 3
  s_lshr_b32 s43, s2, 2
  s_and_b32 s44, s2, 7
  s_lshr_b32 s45, s2, 3
  v_lshrrev_b32 v9, 4, v1
  v_and_b32 v15, 15, v1
  v_lshl_add_u32 v28, v15, 2, v9
  v_lshl_add_u32 v28, s67, 6, v28
  v_lshl_add_u32 v11, s42, 8, v28
  v_lshlrev_b32 v11, 1, v11
  v_mov_b32 v14, 0
  global_load_short_d16_hi v14, v11, s[36:37]
  s_load_dword s66, s[64:65], 12
  s_getpc_b64 s[32:33]
L_pc:
  s_sub_u32 s32, s32, L_pc-adaLN_cond__gqa_block_cached__mixer_token_mlp__decode_kernel
  s_subb_u32 s33, s33, 0
  s_bfe_u32 s30, s2, 0x30003
  s_lshl_b32 s30, s30, 2
  s_add_u32 s30, s30, s67
  s_lshl_b32 s30, s30, 10
  s_min_u32 s30, s30, L_code_end-adaLN_cond__gqa_block_cached__mixer_token_mlp__decode_kernel-1024
  s_add_u32 s32, s32, s30
  s_addc_u32 s33, s33, 0
  s_load_dword s70, s[32:33], 0
  s_load_dword s71, s[32:33], 128
  s_load_dword s72, s[32:33], 256
  s_load_dword s73, s[32:33], 384
  s_load_dword s74, s[32:33], 512
  s_load_dword s75, s[32:33], 640
  s_load_dword s76, s[32:33], 768
  s_load_dword s77, s[32:33], 896
  v_mov_b32 v2, 147456
  v_mov_b32 v3, 1
  s_mov_b32 s6, 0x4000000
  s_mov_b32 s7, 0x20000
  s_mov_b32 s10, 0x4000000
  s_mov_b32 s11, 0x20000
  s_mov_b32 s14, 0x10000000
  s_mov_b32 s15, 0x20000
  s_mov_b32 s22, 0x800000
  s_mov_b32 s23, 0x20000
  s_mov_b64 s[4:5], s[38:39]
  s_mov_b64 s[8:9], s[40:41]
  s_mov_b64 s[12:13], s[64:65]
  s_and_b32 s30, s2, 63
  s_add_u32 s30, s30, s67
  s_cmp_lg_u32 s30, 0
  s_cbranch_scc1 RZ_74
  s_lshl_b32 s30, s2, 6
  s_add_u32 s30, s30, 393216
  v_lshlrev_b32 v11, 2, v1
  v_mov_b32 v24, 0
  s_mov_b32 exec_lo, 0xffffffff
  s_mov_b32 exec_hi, 0x0
  buffer_store_dword v24, v11, s[12:15], s30 offen sc1
  s_mov_b64 exec, -1
  s_waitcnt vmcnt(0)
RZ_74:
  v_lshrrev_b32 v11, 2, v1
  v_lshlrev_b32 v6, 7, v11
  v_and_b32 v11, 6, v11
  v_lshrrev_b32 v24, 1, v1
  v_and_b32 v24, 1, v24
  v_lshl_add_u32 v24, s67, 1, v24
  v_xor_b32 v11, v11, v24
  v_lshl_add_u32 v6, v11, 4, v6
  v_and_b32 v11, 1, v1
  v_lshl_add_u32 v6, v11, 3, v6
  v_add_u32 v6, 131072, v6
  v_add_u32 v7, 0xffff8000, v6
  v_lshl_add_u32 v8, v9, 3, v2
  v_lshlrev_b32 v29, 4, v9
  s_waitcnt vmcnt(3) lgkmcnt(0)
  s_mov_b32 s30, 0xbfb8aa3b
  v_lshlrev_b32 v24, 16, v12
  v_and_b32 v25, 0xffff0000, v12
  v_lshlrev_b32 v26, 16, v13
  v_and_b32 v27, 0xffff0000, v13
  v_mul_f32 v100, s30, v24
  v_mul_f32 v101, s30, v25
  v_mul_f32 v102, s30, v26
  v_mul_f32 v103, s30, v27
  v_exp_f32 v100, v100
  v_exp_f32 v101, v101
  v_exp_f32 v102, v102
  v_exp_f32 v103, v103
  v_add_f32 v100, 1.0, v100
  v_add_f32 v101, 1.0, v101
  v_add_f32 v102, 1.0, v102
  v_add_f32 v103, 1.0, v103
  v_rcp_f32 v100, v100
  v_rcp_f32 v101, v101
  v_rcp_f32 v102, v102
  v_rcp_f32 v103, v103
  v_mul_f32 v24, v24, v100
  v_mul_f32 v25, v25, v101
  v_mul_f32 v26, v26, v102
  v_mul_f32 v27, v27, v103
  v_cvt_pk_bf16_f32 v12, v24, v25
  v_cvt_pk_bf16_f32 v13, v26, v27
  v_lshl_add_u32 v11, v10, 3, v2
  ds_write_b64 v11, v[12:13] offset:0
  s_mov_b64 exec, 1
  ds_add_u32 v2, v3 offset:5760
  s_mov_b64 exec, -1
  s_add_u32 s66, s66, 1
  s_and_b32 s86, s66, 0xff
  s_xor_b32 s62, s86, 0x5a
  s_lshl_b32 s87, s86, 8
  s_or_b32 s87, s87, s62
  s_mul_i32 s88, s86, 0x1010101
  s_and_b32 s63, s88, 0x3030303
  s_add_u32 s63, s63, 0x30201
  s_xor_b32 s88, s88, 0x5a0000
  s_mov_b32 s89, 0x0c0c0400
  s_mov_b32 s90, 0x04000c0c
  v_mov_b32 v247, 0xffffff00
  s_and_b32 s91, s2, 0xf8
  s_lshl_b32 s46, s44, 13
  s_lshl_b32 s30, s45, 8
  s_add_u32 s46, s46, s30
  s_lshl_b32 s30, s67, 6
  s_add_u32 s46, s46, s30
  s_add_u32 s46, s46, 65536
  s_mov_b32 s69, 524288
W_75:
  ds_read_b32 v11, v2 offset:5760
  s_waitcnt lgkmcnt(0)
  v_readfirstlane_b32 s30, v11
  s_nop 0
  s_cmp_ge_u32 s30, 8
  s_cbranch_scc1 WD_76
  s_sub_u32 s69, s69, 1
  s_cbranch_scc0 W_75
WD_76:
  ds_read_b64_tr_b16 v[32:33], v6 offset:0
  ds_read_b64_tr_b16 v[34:35], v6 offset:2048
  ds_read_b64_tr_b16 v[36:37], v6 offset:4096
  ds_read_b64_tr_b16 v[38:39], v6 offset:6144
  ds_read_b64_tr_b16 v[40:41], v6 offset:8192
  ds_read_b64_tr_b16 v[42:43], v6 offset:10240
  ds_read_b64_tr_b16 v[44:45], v6 offset:12288
  ds_read_b64_tr_b16 v[46:47], v6 offset:14336
  v_lshl_add_u32 v11, s44, 8, v8
  ds_read2_b64 v[64:67], v11 offset0:0 offset1:4
  ds_read2_b64 v[68:71], v11 offset0:8 offset1:12
  ds_read2_b64 v[72:75], v11 offset0:16 offset1:20
  ds_read2_b64 v[76:79], v11 offset0:24 offset1:28
  s_waitcnt lgkmcnt(3)
  v_mfma_f32_16x16x32_bf16 v[96:99], v[32:35], v[64:67], 0
  s_waitcnt lgkmcnt(2)
  v_mfma_f32_16x16x32_bf16 v[96:99], v[36:39], v[68:71], v[96:99]
  s_waitcnt lgkmcnt(1)
  v_mfma_f32_16x16x32_bf16 v[96:99], v[40:43], v[72:75], v[96:99]
  s_waitcnt lgkmcnt(0)
  v_mfma_f32_16x16x32_bf16 v[96:99], v[44:47], v[76:79], v[96:99]
  s_add_u32 s30, s86, 1
  s_nop 6
  v_bfi_b32 v96, 3, s30, v96
  s_add_u32 s30, s86, 2
  v_bfi_b32 v97, 3, s30, v97
  s_add_u32 s30, s86, 3
  v_bfi_b32 v98, 3, s30, v98
  s_add_u32 s30, s86, 4
  v_bfi_b32 v99, 3, s30, v99
  s_mov_b32 exec_lo, 0x10001
  s_mov_b32 exec_hi, 0x10001
  buffer_store_dwordx4 v[96:99], v29, s[12:15], s46 offen sc1
  s_mov_b64 exec, -1
  s_waitcnt vmcnt(1)
  v_lshlrev_b32 v100, 16, v16
  v_and_b32 v101, 0xffff0000, v16
  v_lshlrev_b32 v102, 16, v17
  v_and_b32 v103, 0xffff0000, v17
  v_lshlrev_b32 v104, 16, v18
  v_and_b32 v105, 0xffff0000, v18
  v_lshlrev_b32 v106, 16, v19
  v_and_b32 v107, 0xffff0000, v19
  v_lshlrev_b32 v108, 16, v20
  v_and_b32 v109, 0xffff0000, v20
  v_lshlrev_b32 v110, 16, v21
  v_and_b32 v111, 0xffff0000, v21
  v_lshlrev_b32 v112, 16, v22
  v_and_b32 v113, 0xffff0000, v22
  v_lshlrev_b32 v114, 16, v23
  v_and_b32 v115, 0xffff0000, v23
  v_add_f32 v16, v100, v101
  v_add_f32 v16, v16, v102
  v_add_f32 v16, v16, v103
  v_add_f32 v16, v16, v104
  v_add_f32 v16, v16, v105
  v_add_f32 v16, v16, v106
  v_add_f32 v16, v16, v107
  v_add_f32 v16, v16, v108
  v_add_f32 v16, v16, v109
  v_add_f32 v16, v16, v110
  v_add_f32 v16, v16, v111
  v_add_f32 v16, v16, v112
  v_add_f32 v16, v16, v113
  v_add_f32 v16, v16, v114
  v_add_f32 v16, v16, v115
  s_nop 1
  v_add_f32_dpp v16, v16, v16 quad_perm:[1,0,3,2] row_mask:0xf bank_mask:0xf
  s_nop 1
  v_add_f32_dpp v16, v16, v16 quad_perm:[2,3,0,1] row_mask:0xf bank_mask:0xf
  s_nop 1
  v_add_f32_dpp v16, v16, v16 row_half_mirror row_mask:0xf bank_mask:0xf
  s_nop 1
  v_add_f32_dpp v16, v16, v16 row_mirror row_mask:0xf bank_mask:0xf
  v_mov_b32 v17, v16
  s_nop 1
  v_permlane16_swap_b32 v16, v17
  v_add_f32 v16, v16, v17
  v_mov_b32 v17, v16
  s_nop 1
  v_permlane32_swap_b32 v16, v17
  v_add_f32 v16, v16, v17
  v_mul_f32 v16, 0x3a800000, v16
  v_mov_b32 v18, 0
  v_sub_f32 v17, v100, v16
  v_fmac_f32 v18, v17, v17
  v_sub_f32 v17, v101, v16
  v_fmac_f32 v18, v17, v17
  v_sub_f32 v17, v102, v16
  v_fmac_f32 v18, v17, v17
  v_sub_f32 v17, v103, v16
  v_fmac_f32 v18, v17, v17
  v_sub_f32 v17, v104, v16
  v_fmac_f32 v18, v17, v17
  v_sub_f32 v17, v105, v16
  v_fmac_f32 v18, v17, v17
  v_sub_f32 v17, v106, v16
  v_fmac_f32 v18, v17, v17
  v_sub_f32 v17, v107, v16
  v_fmac_f32 v18, v17, v17
  v_sub_f32 v17, v108, v16
  v_fmac_f32 v18, v17, v17
  v_sub_f32 v17, v109, v16
  v_fmac_f32 v18, v17, v17
  v_sub_f32 v17, v110, v16
  v_fmac_f32 v18, v17, v17
  v_sub_f32 v17, v111, v16
  v_fmac_f32 v18, v17, v17
  v_sub_f32 v17, v112, v16
  v_fmac_f32 v18, v17, v17
  v_sub_f32 v17, v113, v16
  v_fmac_f32 v18, v17, v17
  v_sub_f32 v17, v114, v16
  v_fmac_f32 v18, v17, v17
  v_sub_f32 v17, v115, v16
  v_fmac_f32 v18, v17, v17
  s_nop 1
  v_add_f32_dpp v18, v18, v18 quad_perm:[1,0,3,2] row_mask:0xf bank_mask:0xf
  s_nop 1
  v_add_f32_dpp v18, v18, v18 quad_perm:[2,3,0,1] row_mask:0xf bank_mask:0xf
  s_nop 1
  v_add_f32_dpp v18, v18, v18 row_half_mirror row_mask:0xf bank_mask:0xf
  s_nop 1
  v_add_f32_dpp v18, v18, v18 row_mirror row_mask:0xf bank_mask:0xf
  v_mov_b32 v17, v18
  s_nop 1
  v_permlane16_swap_b32 v18, v17
  v_add_f32 v18, v18, v17
  v_mov_b32 v17, v18
  s_nop 1
  v_permlane32_swap_b32 v18, v17
  v_add_f32 v18, v18, v17
  v_mul_f32 v18, 0x3a800000, v18
  v_cvt_pk_bf16_f32 v18, 0, v18
  v_cvt_pk_bf16_f32 v16, 0, v16
  v_add_f32 v18, 0x3727c5ac, v18
  v_cvt_pk_bf16_f32 v18, 0, v18
  v_sqrt_f32 v18, v18
  s_nop 0
  v_cvt_pk_bf16_f32 v18, 0, v18
  v_rcp_f32 v18, v18
  v_sub_f32 v14, v14, v16
  v_cvt_pk_bf16_f32 v14, 0, v14
  v_mul_f32 v14, v14, v18
  v_cvt_pk_bf16_f32 v14, 0, v14
  s_mov_b32 s69, 524288
W_77:
  ds_read_b32 v11, v2 offset:5764
  s_waitcnt lgkmcnt(0)
  v_readfirstlane_b32 s30, v11
  s_nop 0
  s_cmp_ge_u32 s30, 4
  s_cbranch_scc1 WD_78
  s_sleep 1
  s_sub_u32 s69, s69, 1
  s_cbranch_scc0 W_77
WD_78:
  ds_read_b64_tr_b16 v[32:33], v7 offset:0
  ds_read_b64_tr_b16 v[34:35], v7 offset:2048
  ds_read_b64_tr_b16 v[36:37], v7 offset:4096
  ds_read_b64_tr_b16 v[38:39], v7 offset:6144
  ds_read_b64_tr_b16 v[40:41], v7 offset:8192
  ds_read_b64_tr_b16 v[42:43], v7 offset:10240
  ds_read_b64_tr_b16 v[44:45], v7 offset:12288
  ds_read_b64_tr_b16 v[46:47], v7 offset:14336
  ds_read_b64_tr_b16 v[48:49], v7 offset:16384
  ds_read_b64_tr_b16 v[50:51], v7 offset:18432
  ds_read_b64_tr_b16 v[52:53], v7 offset:20480
  ds_read_b64_tr_b16 v[54:55], v7 offset:22528
  ds_read_b64_tr_b16 v[56:57], v7 offset:24576
  ds_read_b64_tr_b16 v[58:59], v7 offset:26624
  ds_read_b64_tr_b16 v[60:61], v7 offset:28672
  ds_read_b64_tr_b16 v[62:63], v7 offset:30720
  s_waitcnt lgkmcnt(0)
  s_mov_b64 exec, 1
  ds_add_u32 v2, v3 offset:5860
  s_mov_b64 exec, -1
  s_lshl_b32 s30, s42, 10
  s_lshl_b32 s31, s67, 8
  s_add_u32 s30, s30, s31
  v_lshl_add_u32 v12, v15, 4, s30
  v_lshl_add_u32 v12, v9, 13, v12
  s_mov_b32 s69, 524288
W_79:
  ds_read_b32 v11, v2 offset:5800
  s_waitcnt lgkmcnt(0)
  v_readfirstlane_b32 s30, v11
  s_nop 0
  s_cmp_ge_u32 s30, 2
  s_cbranch_scc1 WD_80
  s_sleep 2
  s_sub_u32 s69, s69, 1
  s_cbranch_scc0 W_79
WD_80:
  s_mov_b32 s92, 0x10000
  s_mov_b32 s93, 0x18000
  s_mov_b32 s94, 0x11000
  s_mov_b32 s95, 0x19000
  buffer_load_dwordx4 v[100:103], v12, s[12:15], s92 offen offset:0 sc1
  buffer_load_dwordx4 v[104:107], v12, s[12:15], s93 offen offset:0 sc1
  buffer_load_dwordx4 v[108:111], v12, s[12:15], s94 offen offset:0 sc1
  buffer_load_dwordx4 v[112:115], v12, s[12:15], s95 offen offset:0 sc1
  s_mov_b32 s69, 524288
G_81:
  s_waitcnt vmcnt(3)
  v_perm_b32 v26, v101, v100, s89
  v_perm_b32 v27, v103, v102, s90
  v_or_b32 v26, v26, v27
  v_xor_b32 v26, s63, v26
  v_and_b32 v26, 0x03030303, v26
  v_cmp_ne_u32 s[70:71], 0, v26
  s_waitcnt vmcnt(2)
  v_perm_b32 v26, v105, v104, s89
  v_perm_b32 v27, v107, v106, s90
  v_or_b32 v26, v26, v27
  v_xor_b32 v26, s63, v26
  v_and_b32 v26, 0x03030303, v26
  v_cmp_ne_u32 s[72:73], 0, v26
  s_waitcnt vmcnt(1)
  v_perm_b32 v26, v109, v108, s89
  v_perm_b32 v27, v111, v110, s90
  v_or_b32 v26, v26, v27
  v_xor_b32 v26, s63, v26
  v_and_b32 v26, 0x03030303, v26
  v_cmp_ne_u32 s[74:75], 0, v26
  s_waitcnt vmcnt(0)
  v_perm_b32 v26, v113, v112, s89
  v_perm_b32 v27, v115, v114, s90
  v_or_b32 v26, v26, v27
  v_xor_b32 v26, s63, v26
  v_and_b32 v26, 0x03030303, v26
  v_cmp_ne_u32 s[76:77], 0, v26
  s_or_b64 s[28:29], s[70:71], s[72:73]
  s_or_b64 s[28:29], s[28:29], s[74:75]
  s_or_b64 s[28:29], s[28:29], s[76:77]
  s_cbranch_scc0 GD_82
GT_83:
  s_sub_u32 s69, s69, 1
  s_cbranch_scc1 GX_84
  s_sleep 16
  s_wqm_b64 exec, s[70:71]
  s_cbranch_execz GS_85
  buffer_load_dwordx4 v[100:103], v12, s[12:15], s92 offen offset:0 sc1
GS_85:
  s_wqm_b64 exec, s[72:73]
  s_cbranch_execz GS_86
  buffer_load_dwordx4 v[104:107], v12, s[12:15], s93 offen offset:0 sc1
GS_86:
  s_wqm_b64 exec, s[74:75]
  s_cbranch_execz GS_87
  buffer_load_dwordx4 v[108:111], v12, s[12:15], s94 offen offset:0 sc1
GS_87:
  s_wqm_b64 exec, s[76:77]
  s_cbranch_execz GS_88
  buffer_load_dwordx4 v[112:115], v12, s[12:15], s95 offen offset:0 sc1
GS_88:
  s_mov_b64 exec, -1
  s_waitcnt vmcnt(0)
  s_branch G_81
GD_82:
GX_84:
  v_and_b32 v100, -4, v100
  v_and_b32 v101, -4, v101
  v_and_b32 v102, -4, v102
  v_and_b32 v103, -4, v103
  v_and_b32 v104, -4, v104
  v_and_b32 v105, -4, v105
  v_and_b32 v106, -4, v106
  v_and_b32 v107, -4, v107
  v_and_b32 v108, -4, v108
  v_and_b32 v109, -4, v109
  v_and_b32 v110, -4, v110
  v_and_b32 v111, -4, v111
  v_and_b32 v112, -4, v112
  v_and_b32 v113, -4, v113
  v_and_b32 v114, -4, v114
  v_and_b32 v115, -4, v115
  v_pk_add_f32 v[100:101], v[100:101], v[104:105]
  v_pk_add_f32 v[102:103], v[102:103], v[106:107]
  s_nop 1
  v_permlane32_swap_b32 v100, v102
  v_permlane32_swap_b32 v101, v103
  v_pk_add_f32 v[100:101], v[100:101], v[102:103]
  s_nop 1
  v_permlane16_swap_b32 v100, v101
  v_add_f32 v100, v100, v101
  v_cvt_pk_bf16_f32 v100, 0, v100
  v_pk_add_f32 v[108:109], v[108:109], v[112:113]
  v_pk_add_f32 v[110:111], v[110:111], v[114:115]
  s_nop 1
  v_permlane32_swap_b32 v108, v110
  v_permlane32_swap_b32 v109, v111
  v_pk_add_f32 v[108:109], v[108:109], v[110:111]
  s_nop 1
  v_permlane16_swap_b32 v108, v109
  v_add_f32 v108, v108, v109
  v_cvt_pk_bf16_f32 v108, 0, v108
  v_add_f32 v108, 1.0, v108
  v_cvt_pk_bf16_f32 v108, 0, v108
  v_mul_f32 v14, v14, v108
  v_cvt_pk_bf16_f32 v14, 0, v14
  v_add_f32 v14, v14, v100
  v_cvt_pk_bf16_f32 v14, 0, v14
  v_lshl_add_u32 v11, v28, 1, v2
  ds_write_b16_d16_hi v11, v14 offset:4352
  s_mov_b64 exec, 1
  ds_add_u32 v2, v3 offset:5768
  s_mov_b64 exec, -1
  s_lshl_b32 s47, s42, 14
  s_lshl_b32 s30, s43, 8
  s_add_u32 s47, s47, s30
  s_lshl_b32 s30, s67, 6
  s_add_u32 s47, s47, s30
  s_add_u32 s46, s47, 131072
  s_mov_b32 s69, 524288
W_89:
  ds_read_b32 v11, v2 offset:5768
  s_waitcnt lgkmcnt(0)
  v_readfirstlane_b32 s30, v11
  s_nop 0
  s_cmp_ge_u32 s30, 4
  s_cbranch_scc1 WD_90
  s_sub_u32 s69, s69, 1
  s_cbranch_scc0 W_89
WD_90:
  v_add_u32 v11, 4352, v8
  ds_read2_b64 v[64:67], v11 offset0:0 offset1:4
  ds_read2_b64 v[68:71], v11 offset0:8 offset1:12
  ds_read2_b64 v[72:75], v11 offset0:16 offset1:20
  ds_read2_b64 v[76:79], v11 offset0:24 offset1:28
  ds_read2_b64 v[80:83], v11 offset0:32 offset1:36
  ds_read2_b64 v[84:87], v11 offset0:40 offset1:44
  ds_read2_b64 v[88:91], v11 offset0:48 offset1:52
  ds_read2_b64 v[92:95], v11 offset0:56 offset1:60
  s_waitcnt lgkmcnt(7)
  v_mfma_f32_16x16x32_bf16 v[96:99], v[32:35], v[64:67], 0
  s_waitcnt lgkmcnt(6)
  v_mfma_f32_16x16x32_bf16 v[96:99], v[36:39], v[68:71], v[96:99]
  s_waitcnt lgkmcnt(5)
  v_mfma_f32_16x16x32_bf16 v[96:99], v[40:43], v[72:75], v[96:99]
  s_waitcnt lgkmcnt(4)
  v_mfma_f32_16x16x32_bf16 v[96:99], v[44:47], v[76:79], v[96:99]
  s_waitcnt lgkmcnt(3)
  v_mfma_f32_16x16x32_bf16 v[96:99], v[48:51], v[80:83], v[96:99]
  s_waitcnt lgkmcnt(2)
  v_mfma_f32_16x16x32_bf16 v[96:99], v[52:55], v[84:87], v[96:99]
  s_waitcnt lgkmcnt(1)
  v_mfma_f32_16x16x32_bf16 v[96:99], v[56:59], v[88:91], v[96:99]
  s_waitcnt lgkmcnt(0)
  v_mfma_f32_16x16x32_bf16 v[96:99], v[60:63], v[92:95], v[96:99]
  s_add_u32 s30, s86, 1
  s_nop 6
  v_bfi_b32 v96, 3, s30, v96
  s_add_u32 s30, s86, 2
  v_bfi_b32 v97, 3, s30, v97
  s_add_u32 s30, s86, 3
  v_bfi_b32 v98, 3, s30, v98
  s_add_u32 s30, s86, 4
  v_bfi_b32 v99, 3, s30, v99
  s_mov_b32 exec_lo, 0x10001
  s_mov_b32 exec_hi, 0x10001
  buffer_store_dwordx4 v[96:99], v29, s[12:15], s46 offen sc1
  s_mov_b64 exec, -1
  v_lshlrev_b32 v12, 4, v1
  s_lshr_b32 s30, s2, 6
  s_lshl_b32 s30, s30, 12
  s_lshl_b32 s32, s67, 10
  s_add_u32 s30, s30, s32
  v_add_u32 v12, s30, v12
  s_mov_b32 s69, 524288
W_91:
  ds_read_b32 v11, v2 offset:5804
  s_waitcnt lgkmcnt(0)
  v_readfirstlane_b32 s30, v11
  s_nop 0
  s_cmp_ge_u32 s30, 2
  s_cbranch_scc1 WD_92
  s_sleep 2
  s_sub_u32 s69, s69, 1
  s_cbranch_scc0 W_91
WD_92:
  s_mov_b32 s92, 0x20000
  s_mov_b32 s93, 0x24000
  s_mov_b32 s94, 0x28000
  s_mov_b32 s95, 0x2c000
  buffer_load_dwordx4 v[100:103], v12, s[12:15], s92 offen offset:0 sc1
  buffer_load_dwordx4 v[104:107], v12, s[12:15], s93 offen offset:0 sc1
  buffer_load_dwordx4 v[108:111], v12, s[12:15], s94 offen offset:0 sc1
  buffer_load_dwordx4 v[112:115], v12, s[12:15], s95 offen offset:0 sc1
  s_mov_b32 s69, 524288
G_93:
  s_waitcnt vmcnt(3)
  v_perm_b32 v26, v101, v100, s89
  v_perm_b32 v27, v103, v102, s90
  v_or_b32 v26, v26, v27
  v_xor_b32 v26, s63, v26
  v_and_b32 v26, 0x03030303, v26
  v_cmp_ne_u32 s[70:71], 0, v26
  s_waitcnt vmcnt(2)
  v_perm_b32 v26, v105, v104, s89
  v_perm_b32 v27, v107, v106, s90
  v_or_b32 v26, v26, v27
  v_xor_b32 v26, s63, v26
  v_and_b32 v26, 0x03030303, v26
  v_cmp_ne_u32 s[72:73], 0, v26
  s_waitcnt vmcnt(1)
  v_perm_b32 v26, v109, v108, s89
  v_perm_b32 v27, v111, v110, s90
  v_or_b32 v26, v26, v27
  v_xor_b32 v26, s63, v26
  v_and_b32 v26, 0x03030303, v26
  v_cmp_ne_u32 s[74:75], 0, v26
  s_waitcnt vmcnt(0)
  v_perm_b32 v26, v113, v112, s89
  v_perm_b32 v27, v115, v114, s90
  v_or_b32 v26, v26, v27
  v_xor_b32 v26, s63, v26
  v_and_b32 v26, 0x03030303, v26
  v_cmp_ne_u32 s[76:77], 0, v26
  s_or_b64 s[28:29], s[70:71], s[72:73]
  s_or_b64 s[28:29], s[28:29], s[74:75]
  s_or_b64 s[28:29], s[28:29], s[76:77]
  s_cbranch_scc0 GD_94
GT_95:
  s_sub_u32 s69, s69, 1
  s_cbranch_scc1 GX_96
  s_sleep 16
  s_wqm_b64 exec, s[70:71]
  s_cbranch_execz GS_97
  buffer_load_dwordx4 v[100:103], v12, s[12:15], s92 offen offset:0 sc1
GS_97:
  s_wqm_b64 exec, s[72:73]
  s_cbranch_execz GS_98
  buffer_load_dwordx4 v[104:107], v12, s[12:15], s93 offen offset:0 sc1
GS_98:
  s_wqm_b64 exec, s[74:75]
  s_cbranch_execz GS_99
  buffer_load_dwordx4 v[108:111], v12, s[12:15], s94 offen offset:0 sc1
GS_99:
  s_wqm_b64 exec, s[76:77]
  s_cbranch_execz GS_100
  buffer_load_dwordx4 v[112:115], v12, s[12:15], s95 offen offset:0 sc1
GS_100:
  s_mov_b64 exec, -1
  s_waitcnt vmcnt(0)
  s_branch G_93
GD_94:
GX_96:
  v_and_b32 v100, -4, v100
  v_and_b32 v101, -4, v101
  v_and_b32 v102, -4, v102
  v_and_b32 v103, -4, v103
  v_and_b32 v104, -4, v104
  v_and_b32 v105, -4, v105
  v_and_b32 v106, -4, v106
  v_and_b32 v107, -4, v107
  v_and_b32 v108, -4, v108
  v_and_b32 v109, -4, v109
  v_and_b32 v110, -4, v110
  v_and_b32 v111, -4, v111
  v_and_b32 v112, -4, v112
  v_and_b32 v113, -4, v113
  v_and_b32 v114, -4, v114
  v_and_b32 v115, -4, v115
  v_pk_add_f32 v[100:101], v[100:101], v[104:105]
  v_pk_add_f32 v[108:109], v[108:109], v[112:113]
  v_pk_add_f32 v[100:101], v[100:101], v[108:109]
  v_pk_add_f32 v[102:103], v[102:103], v[106:107]
  v_pk_add_f32 v[110:111], v[110:111], v[114:115]
  v_pk_add_f32 v[102:103], v[102:103], v[110:111]
  v_cvt_pk_bf16_f32 v100, v100, v101
  v_cvt_pk_bf16_f32 v101, v102, v103
  s_mul_i32 s30, s67, 544
  v_lshrrev_b32 v11, 5, v1
  v_lshlrev_b32 v11, 4, v11
  v_lshl_add_u32 v11, v1, 3, v11
  v_add3_u32 v11, v11, v2, s30
  ds_write_b64 v11, v[100:101] offset:2048
  s_mov_b64 exec, 1
  ds_add_u32 v2, v3 offset:5772
  s_mov_b64 exec, -1
  s_setprio 0
  v_lshlrev_b32 v11, 2, v10
  v_add_u32 v12, 0x1000, v11
  v_mov_b32 v17, 0
  v_mov_b32 v159, 0
  global_load_dword v100, v11, s[48:49] offset:0
  global_load_dword v101, v11, s[48:49] offset:1024
  global_load_dword v102, v11, s[48:49] offset:2048
  global_load_dword v103, v11, s[48:49] offset:3072
  global_load_dword v104, v12, s[48:49] offset:0
  global_load_dword v105, v12, s[48:49] offset:1024
  global_load_dword v106, v12, s[48:49] offset:2048
  global_load_dword v107, v11, s[50:51] offset:0
  global_load_dword v108, v11, s[50:51] offset:1024
  global_load_dword v109, v11, s[50:51] offset:2048
  global_load_dword v110, v11, s[50:51] offset:3072
  global_load_dword v111, v12, s[50:51] offset:0
  global_load_dword v112, v12, s[50:51] offset:1024
  global_load_dword v113, v12, s[50:51] offset:2048
  global_load_dword v114, v11, s[52:53] offset:0
  global_load_dword v115, v11, s[52:53] offset:1024
  global_load_dword v116, v11, s[52:53] offset:2048
  global_load_dword v117, v11, s[52:53] offset:3072
  global_load_dword v118, v12, s[52:53] offset:0
  global_load_dword v119, v12, s[52:53] offset:1024
  global_load_dword v120, v12, s[52:53] offset:2048
  global_load_short_d16_hi v159, v17, s[54:55]
  v_mov_b32 v44, 0xbdd2d3e8
  v_mov_b32 v45, 0xc0135761
  v_lshl_add_u32 v13, v9, 2, v2
  v_lshl_add_u32 v13, s67, 7, v13
  s_lshl_b32 s39, s2, 5
  s_and_b32 s40, s39, 0xfff
  s_add_u32 s40, s40, 12928
  s_lshr_b32 s30, s39, 12
  s_lshl_b32 s30, s30, 15
  s_or_b32 s40, s40, s30
  s_lshl_b32 s40, s40, 16
  s_mov_b32 s41, 0
  s_waitcnt vmcnt(0)
  v_lshlrev_b32 v160, 16, v100
  v_and_b32 v161, 0xffff0000, v100
  v_lshlrev_b32 v162, 16, v101
  v_and_b32 v163, 0xffff0000, v101
  v_lshlrev_b32 v164, 16, v102
  v_and_b32 v165, 0xffff0000, v102
  v_lshlrev_b32 v166, 16, v103
  v_and_b32 v167, 0xffff0000, v103
  v_lshlrev_b32 v168, 16, v104
  v_and_b32 v169, 0xffff0000, v104
  v_lshlrev_b32 v170, 16, v105
  v_and_b32 v171, 0xffff0000, v105
  v_lshlrev_b32 v172, 16, v106
  v_and_b32 v173, 0xffff0000, v106
  v_lshlrev_b32 v174, 16, v107
  v_and_b32 v175, 0xffff0000, v107
  v_lshlrev_b32 v176, 16, v108
  v_and_b32 v177, 0xffff0000, v108
  v_lshlrev_b32 v178, 16, v109
  v_and_b32 v179, 0xffff0000, v109
  v_lshlrev_b32 v180, 16, v110
  v_and_b32 v181, 0xffff0000, v110
  v_lshlrev_b32 v182, 16, v111
  v_and_b32 v183, 0xffff0000, v111
  v_lshlrev_b32 v184, 16, v112
  v_and_b32 v185, 0xffff0000, v112
  v_lshlrev_b32 v186, 16, v113
  v_and_b32 v187, 0xffff0000, v113
  v_lshlrev_b32 v188, 16, v114
  v_and_b32 v189, 0xffff0000, v114
  v_lshlrev_b32 v190, 16, v115
  v_and_b32 v191, 0xffff0000, v115
  v_lshlrev_b32 v192, 16, v116
  v_and_b32 v193, 0xffff0000, v116
  v_lshlrev_b32 v194, 16, v117
  v_and_b32 v195, 0xffff0000, v117
  v_lshlrev_b32 v196, 16, v118
  v_and_b32 v197, 0xffff0000, v118
  v_lshlrev_b32 v198, 16, v119
  v_and_b32 v199, 0xffff0000, v119
  v_lshlrev_b32 v200, 16, v120
  v_and_b32 v201, 0xffff0000, v120
  s_cmp_lg_u32 s67, 2
  s_cbranch_scc1 ET_101
  s_and_b32 s30, s2, 7
  s_cmp_lg_u32 s30, 0
  s_cbranch_scc1 ET_101
  v_lshlrev_b32 v11, 7, v1
  v_lshl_add_u32 v11, s91, 10, v11
  s_mov_b32 s30, 524288
  buffer_load_dword v250, v11, s[12:15], s30 offen sc1
  v_and_b32 v11, 15, v1
  v_lshlrev_b32 v11, 12, v11
  v_lshl_add_u32 v11, s91, 4, v11
  s_mov_b32 s30, 196608
  buffer_load_dword v251, v11, s[12:15], s30 offen sc1
  v_lshlrev_b32 v11, 4, v1
  s_mov_b32 s30, 327680
  s_mov_b32 s31, 335872
  buffer_load_dword v252, v11, s[12:15], s30 offen sc1
  buffer_load_dword v253, v11, s[12:15], s31 offen sc1
ET_101:
  s_cmp_lg_u32 s67, 1
  s_cbranch_scc1 DP_102
  s_and_b32 s30, s2, 7
  s_cmp_lg_u32 s30, 0
  s_cbranch_scc1 DP_102
  s_getreg_b32 s30, hwreg(HW_REG_XCC_ID)
  s_and_b32 s30, s30, 15
  v_mov_b32 v248, s66
  v_mov_b32 v249, s30
  v_mov_b32 v11, s91
  s_mov_b32 s30, 344064
  s_mov_b64 exec, 1
  buffer_store_dwordx2 v[248:249], v11, s[12:15], s30 offen sc1
  s_mov_b64 exec, -1
DP_102:
L_tab:
  v_mov_b32 v40, s40
  s_add_u32 s40, s40, 0x10000
  v_mov_b32 v16, 0
  v_mov_b32 v41, s40
  s_add_u32 s40, s40, 0x10000
  v_mov_b32 v17, 0
  v_mov_b32 v42, s40
  s_add_u32 s40, s40, 0x10000
  v_mov_b32 v18, 0
  v_mov_b32 v43, s40
  s_add_u32 s40, s40, 0x10000
  v_mov_b32 v19, 0
  s_add_u32 s39, s39, 4
  s_cmp_lg_u32 s39, 4096
  s_cbranch_scc1 TZ_103
  v_mov_b32 v43, 0
TZ_103:
  v_pk_fma_f32 v[48:49], v[40:41], v[160:161], v[174:175] op_sel:[0,0,0] op_sel_hi:[1,0,0]
  v_pk_fma_f32 v[50:51], v[42:43], v[160:161], v[174:175] op_sel:[0,0,0] op_sel_hi:[1,0,0]
  v_pk_fma_f32 v[52:53], v[40:41], v[160:161], v[174:175] op_sel:[0,1,1] op_sel_hi:[1,1,1]
  v_pk_fma_f32 v[54:55], v[42:43], v[160:161], v[174:175] op_sel:[0,1,1] op_sel_hi:[1,1,1]
  v_pk_mul_f32 v[64:65], v[48:49], v[48:49]
  v_pk_mul_f32 v[66:67], v[50:51], v[50:51]
  v_pk_mul_f32 v[68:69], v[52:53], v[52:53]
  v_pk_mul_f32 v[70:71], v[54:55], v[54:55]
  v_pk_fma_f32 v[64:65], v[64:65], v[44:45], v[44:45] op_sel:[0,0,1] op_sel_hi:[1,0,1]
  v_pk_fma_f32 v[66:67], v[66:67], v[44:45], v[44:45] op_sel:[0,0,1] op_sel_hi:[1,0,1]
  v_pk_fma_f32 v[68:69], v[68:69], v[44:45], v[44:45] op_sel:[0,0,1] op_sel_hi:[1,0,1]
  v_pk_fma_f32 v[70:71], v[70:71], v[44:45], v[44:45] op_sel:[0,0,1] op_sel_hi:[1,0,1]
  v_pk_mul_f32 v[64:65], v[64:65], v[48:49]
  v_pk_mul_f32 v[66:67], v[66:67], v[50:51]
  v_pk_mul_f32 v[68:69], v[68:69], v[52:53]
  v_pk_mul_f32 v[70:71], v[70:71], v[54:55]
  v_exp_f32 v64, v64
  v_exp_f32 v65, v65
  v_exp_f32 v66, v66
  v_exp_f32 v67, v67
  v_exp_f32 v68, v68
  v_exp_f32 v69, v69
  v_exp_f32 v70, v70
  v_exp_f32 v71, v71
  v_pk_add_f32 v[64:65], v[64:65], 1.0 op_sel_hi:[1,0]
  v_pk_add_f32 v[66:67], v[66:67], 1.0 op_sel_hi:[1,0]
  v_pk_add_f32 v[68:69], v[68:69], 1.0 op_sel_hi:[1,0]
  v_pk_add_f32 v[70:71], v[70:71], 1.0 op_sel_hi:[1,0]
  v_rcp_f32 v64, v64
  v_rcp_f32 v65, v65
  v_rcp_f32 v66, v66
  v_rcp_f32 v67, v67
  v_rcp_f32 v68, v68
  v_rcp_f32 v69, v69
  v_rcp_f32 v70, v70
  v_rcp_f32 v71, v71
  v_pk_mul_f32 v[48:49], v[48:49], v[64:65]
  v_pk_mul_f32 v[50:51], v[50:51], v[66:67]
  v_pk_mul_f32 v[52:53], v[52:53], v[68:69]
  v_pk_mul_f32 v[54:55], v[54:55], v[70:71]
  v_pk_fma_f32 v[16:17], v[48:49], v[188:189], v[16:17] op_sel:[0,0,0] op_sel_hi:[1,0,1]
  v_pk_fma_f32 v[18:19], v[50:51], v[188:189], v[18:19] op_sel:[0,0,0] op_sel_hi:[1,0,1]
  v_pk_fma_f32 v[16:17], v[52:53], v[188:189], v[16:17] op_sel:[0,1,0] op_sel_hi:[1,1,1]
  v_pk_fma_f32 v[18:19], v[54:55], v[188:189], v[18:19] op_sel:[0,1,0] op_sel_hi:[1,1,1]
  v_pk_fma_f32 v[48:49], v[40:41], v[162:163], v[176:177] op_sel:[0,0,0] op_sel_hi:[1,0,0]
  v_pk_fma_f32 v[50:51], v[42:43], v[162:163], v[176:177] op_sel:[0,0,0] op_sel_hi:[1,0,0]
  v_pk_fma_f32 v[52:53], v[40:41], v[162:163], v[176:177] op_sel:[0,1,1] op_sel_hi:[1,1,1]
  v_pk_fma_f32 v[54:55], v[42:43], v[162:163], v[176:177] op_sel:[0,1,1] op_sel_hi:[1,1,1]
  v_pk_mul_f32 v[64:65], v[48:49], v[48:49]
  v_pk_mul_f32 v[66:67], v[50:51], v[50:51]
  v_pk_mul_f32 v[68:69], v[52:53], v[52:53]
  v_pk_mul_f32 v[70:71], v[54:55], v[54:55]
  v_pk_fma_f32 v[64:65], v[64:65], v[44:45], v[44:45] op_sel:[0,0,1] op_sel_hi:[1,0,1]
  v_pk_fma_f32 v[66:67], v[66:67], v[44:45], v[44:45] op_sel:[0,0,1] op_sel_hi:[1,0,1]
  v_pk_fma_f32 v[68:69], v[68:69], v[44:45], v[44:45] op_sel:[0,0,1] op_sel_hi:[1,0,1]
  v_pk_fma_f32 v[70:71], v[70:71], v[44:45], v[44:45] op_sel:[0,0,1] op_sel_hi:[1,0,1]
  v_pk_mul_f32 v[64:65], v[64:65], v[48:49]
  v_pk_mul_f32 v[66:67], v[66:67], v[50:51]
  v_pk_mul_f32 v[68:69], v[68:69], v[52:53]
  v_pk_mul_f32 v[70:71], v[70:71], v[54:55]
  v_exp_f32 v64, v64
  v_exp_f32 v65, v65
  v_exp_f32 v66, v66
  v_exp_f32 v67, v67
  v_exp_f32 v68, v68
  v_exp_f32 v69, v69
  v_exp_f32 v70, v70
  v_exp_f32 v71, v71
  v_pk_add_f32 v[64:65], v[64:65], 1.0 op_sel_hi:[1,0]
  v_pk_add_f32 v[66:67], v[66:67], 1.0 op_sel_hi:[1,0]
  v_pk_add_f32 v[68:69], v[68:69], 1.0 op_sel_hi:[1,0]
  v_pk_add_f32 v[70:71], v[70:71], 1.0 op_sel_hi:[1,0]
  v_rcp_f32 v64, v64
  v_rcp_f32 v65, v65
  v_rcp_f32 v66, v66
  v_rcp_f32 v67, v67
  v_rcp_f32 v68, v68
  v_rcp_f32 v69, v69
  v_rcp_f32 v70, v70
  v_rcp_f32 v71, v71
  v_pk_mul_f32 v[48:49], v[48:49], v[64:65]
  v_pk_mul_f32 v[50:51], v[50:51], v[66:67]
  v_pk_mul_f32 v[52:53], v[52:53], v[68:69]
  v_pk_mul_f32 v[54:55], v[54:55], v[70:71]
  v_pk_fma_f32 v[16:17], v[48:49], v[190:191], v[16:17] op_sel:[0,0,0] op_sel_hi:[1,0,1]
  v_pk_fma_f32 v[18:19], v[50:51], v[190:191], v[18:19] op_sel:[0,0,0] op_sel_hi:[1,0,1]
  v_pk_fma_f32 v[16:17], v[52:53], v[190:191], v[16:17] op_sel:[0,1,0] op_sel_hi:[1,1,1]
  v_pk_fma_f32 v[18:19], v[54:55], v[190:191], v[18:19] op_sel:[0,1,0] op_sel_hi:[1,1,1]
  v_pk_fma_f32 v[48:49], v[40:41], v[164:165], v[178:179] op_sel:[0,0,0] op_sel_hi:[1,0,0]
  v_pk_fma_f32 v[50:51], v[42:43], v[164:165], v[178:179] op_sel:[0,0,0] op_sel_hi:[1,0,0]
  v_pk_fma_f32 v[52:53], v[40:41], v[164:165], v[178:179] op_sel:[0,1,1] op_sel_hi:[1,1,1]
  v_pk_fma_f32 v[54:55], v[42:43], v[164:165], v[178:179] op_sel:[0,1,1] op_sel_hi:[1,1,1]
  v_pk_mul_f32 v[64:65], v[48:49], v[48:49]
  v_pk_mul_f32 v[66:67], v[50:51], v[50:51]
  v_pk_mul_f32 v[68:69], v[52:53], v[52:53]
  v_pk_mul_f32 v[70:71], v[54:55], v[54:55]
  v_pk_fma_f32 v[64:65], v[64:65], v[44:45], v[44:45] op_sel:[0,0,1] op_sel_hi:[1,0,1]
  v_pk_fma_f32 v[66:67], v[66:67], v[44:45], v[44:45] op_sel:[0,0,1] op_sel_hi:[1,0,1]
  v_pk_fma_f32 v[68:69], v[68:69], v[44:45], v[44:45] op_sel:[0,0,1] op_sel_hi:[1,0,1]
  v_pk_fma_f32 v[70:71], v[70:71], v[44:45], v[44:45] op_sel:[0,0,1] op_sel_hi:[1,0,1]
  v_pk_mul_f32 v[64:65], v[64:65], v[48:49]
  v_pk_mul_f32 v[66:67], v[66:67], v[50:51]
  v_pk_mul_f32 v[68:69], v[68:69], v[52:53]
  v_pk_mul_f32 v[70:71], v[70:71], v[54:55]
  v_exp_f32 v64, v64
  v_exp_f32 v65, v65
  v_exp_f32 v66, v66
  v_exp_f32 v67, v67
  v_exp_f32 v68, v68
  v_exp_f32 v69, v69
  v_exp_f32 v70, v70
  v_exp_f32 v71, v71
  v_pk_add_f32 v[64:65], v[64:65], 1.0 op_sel_hi:[1,0]
  v_pk_add_f32 v[66:67], v[66:67], 1.0 op_sel_hi:[1,0]
  v_pk_add_f32 v[68:69], v[68:69], 1.0 op_sel_hi:[1,0]
  v_pk_add_f32 v[70:71], v[70:71], 1.0 op_sel_hi:[1,0]
  v_rcp_f32 v64, v64
  v_rcp_f32 v65, v65
  v_rcp_f32 v66, v66
  v_rcp_f32 v67, v67
  v_rcp_f32 v68, v68
  v_rcp_f32 v69, v69
  v_rcp_f32 v70, v70
  v_rcp_f32 v71, v71
  v_pk_mul_f32 v[48:49], v[48:49], v[64:65]
  v_pk_mul_f32 v[50:51], v[50:51], v[66:67]
  v_pk_mul_f32 v[52:53], v[52:53], v[68:69]
  v_pk_mul_f32 v[54:55], v[54:55], v[70:71]
  v_pk_fma_f32 v[16:17], v[48:49], v[192:193], v[16:17] op_sel:[0,0,0] op_sel_hi:[1,0,1]
  v_pk_fma_f32 v[18:19], v[50:51], v[192:193], v[18:19] op_sel:[0,0,0] op_sel_hi:[1,0,1]
  v_pk_fma_f32 v[16:17], v[52:53], v[192:193], v[16:17] op_sel:[0,1,0] op_sel_hi:[1,1,1]
  v_pk_fma_f32 v[18:19], v[54:55], v[192:193], v[18:19] op_sel:[0,1,0] op_sel_hi:[1,1,1]
  v_pk_fma_f32 v[48:49], v[40:41], v[166:167], v[180:181] op_sel:[0,0,0] op_sel_hi:[1,0,0]
  v_pk_fma_f32 v[50:51], v[42:43], v[166:167], v[180:181] op_sel:[0,0,0] op_sel_hi:[1,0,0]
  v_pk_fma_f32 v[52:53], v[40:41], v[166:167], v[180:181] op_sel:[0,1,1] op_sel_hi:[1,1,1]
  v_pk_fma_f32 v[54:55], v[42:43], v[166:167], v[180:181] op_sel:[0,1,1] op_sel_hi:[1,1,1]
  v_pk_mul_f32 v[64:65], v[48:49], v[48:49]
  v_pk_mul_f32 v[66:67], v[50:51], v[50:51]
  v_pk_mul_f32 v[68:69], v[52:53], v[52:53]
  v_pk_mul_f32 v[70:71], v[54:55], v[54:55]
  v_pk_fma_f32 v[64:65], v[64:65], v[44:45], v[44:45] op_sel:[0,0,1] op_sel_hi:[1,0,1]
  v_pk_fma_f32 v[66:67], v[66:67], v[44:45], v[44:45] op_sel:[0,0,1] op_sel_hi:[1,0,1]
  v_pk_fma_f32 v[68:69], v[68:69], v[44:45], v[44:45] op_sel:[0,0,1] op_sel_hi:[1,0,1]
  v_pk_fma_f32 v[70:71], v[70:71], v[44:45], v[44:45] op_sel:[0,0,1] op_sel_hi:[1,0,1]
  v_pk_mul_f32 v[64:65], v[64:65], v[48:49]
  v_pk_mul_f32 v[66:67], v[66:67], v[50:51]
  v_pk_mul_f32 v[68:69], v[68:69], v[52:53]
  v_pk_mul_f32 v[70:71], v[70:71], v[54:55]
  v_exp_f32 v64, v64
  v_exp_f32 v65, v65
  v_exp_f32 v66, v66
  v_exp_f32 v67, v67
  v_exp_f32 v68, v68
  v_exp_f32 v69, v69
  v_exp_f32 v70, v70
  v_exp_f32 v71, v71
  v_pk_add_f32 v[64:65], v[64:65], 1.0 op_sel_hi:[1,0]
  v_pk_add_f32 v[66:67], v[66:67], 1.0 op_sel_hi:[1,0]
  v_pk_add_f32 v[68:69], v[68:69], 1.0 op_sel_hi:[1,0]
  v_pk_add_f32 v[70:71], v[70:71], 1.0 op_sel_hi:[1,0]
  v_rcp_f32 v64, v64
  v_rcp_f32 v65, v65
  v_rcp_f32 v66, v66
  v_rcp_f32 v67, v67
  v_rcp_f32 v68, v68
  v_rcp_f32 v69, v69
  v_rcp_f32 v70, v70
  v_rcp_f32 v71, v71
  v_pk_mul_f32 v[48:49], v[48:49], v[64:65]
  v_pk_mul_f32 v[50:51], v[50:51], v[66:67]
  v_pk_mul_f32 v[52:53], v[52:53], v[68:69]
  v_pk_mul_f32 v[54:55], v[54:55], v[70:71]
  v_pk_fma_f32 v[16:17], v[48:49], v[194:195], v[16:17] op_sel:[0,0,0] op_sel_hi:[1,0,1]
  v_pk_fma_f32 v[18:19], v[50:51], v[194:195], v[18:19] op_sel:[0,0,0] op_sel_hi:[1,0,1]
  v_pk_fma_f32 v[16:17], v[52:53], v[194:195], v[16:17] op_sel:[0,1,0] op_sel_hi:[1,1,1]
  v_pk_fma_f32 v[18:19], v[54:55], v[194:195], v[18:19] op_sel:[0,1,0] op_sel_hi:[1,1,1]
  v_pk_fma_f32 v[48:49], v[40:41], v[168:169], v[182:183] op_sel:[0,0,0] op_sel_hi:[1,0,0]
  v_pk_fma_f32 v[50:51], v[42:43], v[168:169], v[182:183] op_sel:[0,0,0] op_sel_hi:[1,0,0]
  v_pk_fma_f32 v[52:53], v[40:41], v[168:169], v[182:183] op_sel:[0,1,1] op_sel_hi:[1,1,1]
  v_pk_fma_f32 v[54:55], v[42:43], v[168:169], v[182:183] op_sel:[0,1,1] op_sel_hi:[1,1,1]
  v_pk_mul_f32 v[64:65], v[48:49], v[48:49]
  v_pk_mul_f32 v[66:67], v[50:51], v[50:51]
  v_pk_mul_f32 v[68:69], v[52:53], v[52:53]
  v_pk_mul_f32 v[70:71], v[54:55], v[54:55]
  v_pk_fma_f32 v[64:65], v[64:65], v[44:45], v[44:45] op_sel:[0,0,1] op_sel_hi:[1,0,1]
  v_pk_fma_f32 v[66:67], v[66:67], v[44:45], v[44:45] op_sel:[0,0,1] op_sel_hi:[1,0,1]
  v_pk_fma_f32 v[68:69], v[68:69], v[44:45], v[44:45] op_sel:[0,0,1] op_sel_hi:[1,0,1]
  v_pk_fma_f32 v[70:71], v[70:71], v[44:45], v[44:45] op_sel:[0,0,1] op_sel_hi:[1,0,1]
  v_pk_mul_f32 v[64:65], v[64:65], v[48:49]
  v_pk_mul_f32 v[66:67], v[66:67], v[50:51]
  v_pk_mul_f32 v[68:69], v[68:69], v[52:53]
  v_pk_mul_f32 v[70:71], v[70:71], v[54:55]
  v_exp_f32 v64, v64
  v_exp_f32 v65, v65
  v_exp_f32 v66, v66
  v_exp_f32 v67, v67
  v_exp_f32 v68, v68
  v_exp_f32 v69, v69
  v_exp_f32 v70, v70
  v_exp_f32 v71, v71
  v_pk_add_f32 v[64:65], v[64:65], 1.0 op_sel_hi:[1,0]
  v_pk_add_f32 v[66:67], v[66:67], 1.0 op_sel_hi:[1,0]
  v_pk_add_f32 v[68:69], v[68:69], 1.0 op_sel_hi:[1,0]
  v_pk_add_f32 v[70:71], v[70:71], 1.0 op_sel_hi:[1,0]
  v_rcp_f32 v64, v64
  v_rcp_f32 v65, v65
  v_rcp_f32 v66, v66
  v_rcp_f32 v67, v67
  v_rcp_f32 v68, v68
  v_rcp_f32 v69, v69
  v_rcp_f32 v70, v70
  v_rcp_f32 v71, v71
  v_pk_mul_f32 v[48:49], v[48:49], v[64:65]
  v_pk_mul_f32 v[50:51], v[50:51], v[66:67]
  v_pk_mul_f32 v[52:53], v[52:53], v[68:69]
  v_pk_mul_f32 v[54:55], v[54:55], v[70:71]
  v_pk_fma_f32 v[16:17], v[48:49], v[196:197], v[16:17] op_sel:[0,0,0] op_sel_hi:[1,0,1]
  v_pk_fma_f32 v[18:19], v[50:51], v[196:197], v[18:19] op_sel:[0,0,0] op_sel_hi:[1,0,1]
  v_pk_fma_f32 v[16:17], v[52:53], v[196:197], v[16:17] op_sel:[0,1,0] op_sel_hi:[1,1,1]
  v_pk_fma_f32 v[18:19], v[54:55], v[196:197], v[18:19] op_sel:[0,1,0] op_sel_hi:[1,1,1]
  v_pk_fma_f32 v[48:49], v[40:41], v[170:171], v[184:185] op_sel:[0,0,0] op_sel_hi:[1,0,0]
  v_pk_fma_f32 v[50:51], v[42:43], v[170:171], v[184:185] op_sel:[0,0,0] op_sel_hi:[1,0,0]
  v_pk_fma_f32 v[52:53], v[40:41], v[170:171], v[184:185] op_sel:[0,1,1] op_sel_hi:[1,1,1]
  v_pk_fma_f32 v[54:55], v[42:43], v[170:171], v[184:185] op_sel:[0,1,1] op_sel_hi:[1,1,1]
  v_pk_mul_f32 v[64:65], v[48:49], v[48:49]
  v_pk_mul_f32 v[66:67], v[50:51], v[50:51]
  v_pk_mul_f32 v[68:69], v[52:53], v[52:53]
  v_pk_mul_f32 v[70:71], v[54:55], v[54:55]
  v_pk_fma_f32 v[64:65], v[64:65], v[44:45], v[44:45] op_sel:[0,0,1] op_sel_hi:[1,0,1]
  v_pk_fma_f32 v[66:67], v[66:67], v[44:45], v[44:45] op_sel:[0,0,1] op_sel_hi:[1,0,1]
  v_pk_fma_f32 v[68:69], v[68:69], v[44:45], v[44:45] op_sel:[0,0,1] op_sel_hi:[1,0,1]
  v_pk_fma_f32 v[70:71], v[70:71], v[44:45], v[44:45] op_sel:[0,0,1] op_sel_hi:[1,0,1]
  v_pk_mul_f32 v[64:65], v[64:65], v[48:49]
  v_pk_mul_f32 v[66:67], v[66:67], v[50:51]
  v_pk_mul_f32 v[68:69], v[68:69], v[52:53]
  v_pk_mul_f32 v[70:71], v[70:71], v[54:55]
  v_exp_f32 v64, v64
  v_exp_f32 v65, v65
  v_exp_f32 v66, v66
  v_exp_f32 v67, v67
  v_exp_f32 v68, v68
  v_exp_f32 v69, v69
  v_exp_f32 v70, v70
  v_exp_f32 v71, v71
  v_pk_add_f32 v[64:65], v[64:65], 1.0 op_sel_hi:[1,0]
  v_pk_add_f32 v[66:67], v[66:67], 1.0 op_sel_hi:[1,0]
  v_pk_add_f32 v[68:69], v[68:69], 1.0 op_sel_hi:[1,0]
  v_pk_add_f32 v[70:71], v[70:71], 1.0 op_sel_hi:[1,0]
  v_rcp_f32 v64, v64
  v_rcp_f32 v65, v65
  v_rcp_f32 v66, v66
  v_rcp_f32 v67, v67
  v_rcp_f32 v68, v68
  v_rcp_f32 v69, v69
  v_rcp_f32 v70, v70
  v_rcp_f32 v71, v71
  v_pk_mul_f32 v[48:49], v[48:49], v[64:65]
  v_pk_mul_f32 v[50:51], v[50:51], v[66:67]
  v_pk_mul_f32 v[52:53], v[52:53], v[68:69]
  v_pk_mul_f32 v[54:55], v[54:55], v[70:71]
  v_pk_fma_f32 v[16:17], v[48:49], v[198:199], v[16:17] op_sel:[0,0,0] op_sel_hi:[1,0,1]
  v_pk_fma_f32 v[18:19], v[50:51], v[198:199], v[18:19] op_sel:[0,0,0] op_sel_hi:[1,0,1]
  v_pk_fma_f32 v[16:17], v[52:53], v[198:199], v[16:17] op_sel:[0,1,0] op_sel_hi:[1,1,1]
  v_pk_fma_f32 v[18:19], v[54:55], v[198:199], v[18:19] op_sel:[0,1,0] op_sel_hi:[1,1,1]
  v_pk_fma_f32 v[48:49], v[40:41], v[172:173], v[186:187] op_sel:[0,0,0] op_sel_hi:[1,0,0]
  v_pk_fma_f32 v[50:51], v[42:43], v[172:173], v[186:187] op_sel:[0,0,0] op_sel_hi:[1,0,0]
  v_pk_fma_f32 v[52:53], v[40:41], v[172:173], v[186:187] op_sel:[0,1,1] op_sel_hi:[1,1,1]
  v_pk_fma_f32 v[54:55], v[42:43], v[172:173], v[186:187] op_sel:[0,1,1] op_sel_hi:[1,1,1]
  v_pk_mul_f32 v[64:65], v[48:49], v[48:49]
  v_pk_mul_f32 v[66:67], v[50:51], v[50:51]
  v_pk_mul_f32 v[68:69], v[52:53], v[52:53]
  v_pk_mul_f32 v[70:71], v[54:55], v[54:55]
  v_pk_fma_f32 v[64:65], v[64:65], v[44:45], v[44:45] op_sel:[0,0,1] op_sel_hi:[1,0,1]
  v_pk_fma_f32 v[66:67], v[66:67], v[44:45], v[44:45] op_sel:[0,0,1] op_sel_hi:[1,0,1]
  v_pk_fma_f32 v[68:69], v[68:69], v[44:45], v[44:45] op_sel:[0,0,1] op_sel_hi:[1,0,1]
  v_pk_fma_f32 v[70:71], v[70:71], v[44:45], v[44:45] op_sel:[0,0,1] op_sel_hi:[1,0,1]
  v_pk_mul_f32 v[64:65], v[64:65], v[48:49]
  v_pk_mul_f32 v[66:67], v[66:67], v[50:51]
  v_pk_mul_f32 v[68:69], v[68:69], v[52:53]
  v_pk_mul_f32 v[70:71], v[70:71], v[54:55]
  v_exp_f32 v64, v64
  v_exp_f32 v65, v65
  v_exp_f32 v66, v66
  v_exp_f32 v67, v67
  v_exp_f32 v68, v68
  v_exp_f32 v69, v69
  v_exp_f32 v70, v70
  v_exp_f32 v71, v71
  v_pk_add_f32 v[64:65], v[64:65], 1.0 op_sel_hi:[1,0]
  v_pk_add_f32 v[66:67], v[66:67], 1.0 op_sel_hi:[1,0]
  v_pk_add_f32 v[68:69], v[68:69], 1.0 op_sel_hi:[1,0]
  v_pk_add_f32 v[70:71], v[70:71], 1.0 op_sel_hi:[1,0]
  v_rcp_f32 v64, v64
  v_rcp_f32 v65, v65
  v_rcp_f32 v66, v66
  v_rcp_f32 v67, v67
  v_rcp_f32 v68, v68
  v_rcp_f32 v69, v69
  v_rcp_f32 v70, v70
  v_rcp_f32 v71, v71
  v_pk_mul_f32 v[48:49], v[48:49], v[64:65]
  v_pk_mul_f32 v[50:51], v[50:51], v[66:67]
  v_pk_mul_f32 v[52:53], v[52:53], v[68:69]
  v_pk_mul_f32 v[54:55], v[54:55], v[70:71]
  v_pk_fma_f32 v[16:17], v[48:49], v[200:201], v[16:17] op_sel:[0,0,0] op_sel_hi:[1,0,1]
  v_pk_fma_f32 v[18:19], v[50:51], v[200:201], v[18:19] op_sel:[0,0,0] op_sel_hi:[1,0,1]
  v_pk_fma_f32 v[16:17], v[52:53], v[200:201], v[16:17] op_sel:[0,1,0] op_sel_hi:[1,1,1]
  v_pk_fma_f32 v[18:19], v[54:55], v[200:201], v[18:19] op_sel:[0,1,0] op_sel_hi:[1,1,1]
  s_nop 1
  v_permlane32_swap_b32 v16, v18
  v_permlane32_swap_b32 v17, v19
  v_pk_add_f32 v[16:17], v[16:17], v[18:19]
  s_nop 1
  v_permlane16_swap_b32 v16, v17
  v_add_f32 v16, v16, v17
  s_nop 1
  v_add_f32_dpp v16, v16, v16 quad_perm:[1,0,3,2] row_mask:0xf bank_mask:0xf
  s_nop 1
  v_add_f32_dpp v16, v16, v16 quad_perm:[2,3,0,1] row_mask:0xf bank_mask:0xf
  s_nop 1
  v_add_f32_dpp v16, v16, v16 row_half_mirror row_mask:0xf bank_mask:0xf
  s_nop 1
  v_add_f32_dpp v16, v16, v16 row_mirror row_mask:0xf bank_mask:0xf
  s_mov_b32 exec_lo, 0x10001
  s_mov_b32 exec_hi, 0x10001
  ds_write_b32 v13, v16 offset:6144
  s_mov_b64 exec, -1
  v_add_u32 v13, 16, v13
  s_add_u32 s41, s41, 1
  s_cmp_lt_u32 s41, 8
  s_cbranch_scc1 L_tab
  s_mov_b64 exec, 1
  ds_add_u32 v2, v3 offset:5824
  s_mov_b64 exec, -1
  s_cmp_lg_u32 s67, 0
  s_cbranch_scc1 X3_104
  s_mov_b32 s69, 524288
W_108:
  ds_read_b32 v11, v2 offset:5824
  s_waitcnt lgkmcnt(0)
  v_readfirstlane_b32 s30, v11
  s_nop 0
  s_cmp_ge_u32 s30, 4
  s_cbranch_scc1 WD_109
  s_sleep 1
  s_sub_u32 s69, s69, 1
  s_cbranch_scc0 W_108
WD_109:
  v_and_b32 v12, 7, v1
  v_lshlrev_b32 v12, 4, v12
  v_add_u32 v11, v2, v12
  ds_read_b128 v[48:51], v11 offset:6144
  ds_read_b128 v[52:55], v11 offset:6272
  ds_read_b128 v[56:59], v11 offset:6400
  ds_read_b128 v[60:63], v11 offset:6528
  s_lshl_b32 s30, s2, 7
  s_add_u32 s30, s30, 425984
  s_waitcnt lgkmcnt(0)
  v_pk_add_f32 v[48:49], v[48:49], v[52:53]
  v_pk_add_f32 v[56:57], v[56:57], v[60:61]
  v_pk_add_f32 v[48:49], v[48:49], v[56:57]
  v_pk_add_f32 v[50:51], v[50:51], v[54:55]
  v_pk_add_f32 v[58:59], v[58:59], v[62:63]
  v_pk_add_f32 v[50:51], v[50:51], v[58:59]
  v_cvt_pk_bf16_f32 v48, 0, v48
  v_cvt_pk_bf16_f32 v49, 0, v49
  v_cvt_pk_bf16_f32 v50, 0, v50
  v_cvt_pk_bf16_f32 v51, 0, v51
  v_add_f32 v48, v48, v159
  v_add_f32 v49, v49, v159
  v_add_f32 v50, v50, v159
  v_add_f32 v51, v51, v159
  v_cvt_pk_bf16_f32 v48, 0, v48
  v_cvt_pk_bf16_f32 v49, 0, v49
  v_cvt_pk_bf16_f32 v50, 0, v50
  v_cvt_pk_bf16_f32 v51, 0, v51
  v_or_b32 v48, s86, v48
  v_or_b32 v49, s86, v49
  v_or_b32 v50, s86, v50
  v_or_b32 v51, s86, v51
  s_mov_b32 exec_lo, 0xff
  s_mov_b32 exec_hi, 0x0
  buffer_store_dwordx4 v[48:51], v12, s[12:15], s30 offen sc1
  s_mov_b64 exec, -1
X3_104:
  s_cmp_lg_u32 s67, 1
  s_cbranch_scc1 DG_110
  s_and_b32 s30, s2, 7
  s_cmp_lg_u32 s30, 0
  s_cbranch_scc1 DG_110
  v_and_b32 v11, 31, v1
  v_lshlrev_b32 v11, 3, v11
  s_mov_b32 s31, 344064
  s_mov_b32 s69, 524288
DL_111:
  buffer_load_dwordx2 v[16:17], v11, s[12:15], s31 offen sc1
  s_waitcnt vmcnt(0)
  v_cmp_ne_u32 vcc, s66, v16
  s_cbranch_vccz DO_112
  s_sleep 8
  s_sub_u32 s69, s69, 1
  s_cbranch_scc0 DL_111
DO_112:
  v_cmp_ne_u32 vcc, v249, v17
  s_nop 0
  s_cmp_eq_u64 vcc, 0
  s_cselect_b32 s30, 1, 2
  v_mov_b32 v16, s30
  ds_write_b32 v2, v16 offset:5868
DG_110:
  s_mov_b32 s69, 524288
W_113:
  ds_read_b32 v11, v2 offset:5820
  s_waitcnt lgkmcnt(0)
  v_readfirstlane_b32 s30, v11
  s_nop 0
  s_cmp_ge_u32 s30, 1
  s_cbranch_scc1 WD_114
  s_sleep 2
  s_sub_u32 s69, s69, 1
  s_cbranch_scc0 W_113
WD_114:
  s_sub_u32 s33, s30, 1
  s_cmp_ge_u32 s33, 32
  s_cbranch_scc1 XM_106
  s_lshr_b32 s38, s33, 1
  s_lshr_b32 s30, s2, 6
  s_lshl_b32 s30, s30, 4
  s_add_u32 s38, s38, s30
  s_cmp_lg_u32 s67, 3
  s_cbranch_scc1 XD_105
  s_lshr_b32 s30, s38, 4
  s_lshl_b32 s30, s30, 13
  s_lshr_b32 s31, s38, 1
  s_and_b32 s31, s31, 7
  s_lshl_b32 s31, s31, 4
  s_add_u32 s30, s30, s31
  v_lshl_add_u32 v12, v1, 7, s30
  s_mov_b32 s92, 0x40000
  buffer_load_dwordx4 v[100:103], v12, s[12:15], s92 offen offset:0 sc1
  s_mov_b32 s69, 524288
G_115:
  s_waitcnt vmcnt(0)
  v_perm_b32 v26, v101, v100, s89
  v_perm_b32 v27, v103, v102, s90
  v_or_b32 v26, v26, v27
  v_cmp_ne_u32 s[70:71], s88, v26
  s_nop 0
  s_or_b64 s[28:29], s[70:71], s[70:71]
  s_cbranch_scc0 GD_116
GT_117:
  s_sub_u32 s69, s69, 1
  s_cbranch_scc1 GX_118
  s_sleep 16
  s_wqm_b64 exec, s[70:71]
  s_cbranch_execz GS_119
  buffer_load_dwordx4 v[100:103], v12, s[12:15], s92 offen offset:0 sc1
GS_119:
  s_mov_b64 exec, -1
  s_waitcnt vmcnt(0)
  s_branch G_115
GD_116:
GX_118:
  v_and_b32 v100, v247, v100
  v_and_b32 v101, v247, v101
  v_mov_b32 v16, v100
  s_nop 1
  v_max_f32_dpp v16, v16, v16 quad_perm:[1,0,3,2] row_mask:0xf bank_mask:0xf
  s_nop 1
  v_max_f32_dpp v16, v16, v16 quad_perm:[2,3,0,1] row_mask:0xf bank_mask:0xf
  s_nop 1
  v_max_f32_dpp v16, v16, v16 row_half_mirror row_mask:0xf bank_mask:0xf
  s_nop 1
  v_max_f32_dpp v16, v16, v16 row_mirror row_mask:0xf bank_mask:0xf
  v_mov_b32 v11, v16
  s_nop 1
  v_permlane16_swap_b32 v16, v11
  v_max_f32 v16, v16, v11
  v_mov_b32 v11, v16
  s_nop 1
  v_permlane32_swap_b32 v16, v11
  v_max_f32 v16, v16, v11
  v_sub_f32 v16, v100, v16
  v_exp_f32 v16, v16
  s_nop 0
  v_mul_f32 v17, v16, v101
  s_nop 1
  v_add_f32_dpp v17, v17, v17 quad_perm:[1,0,3,2] row_mask:0xf bank_mask:0xf
  s_nop 1
  v_add_f32_dpp v17, v17, v17 quad_perm:[2,3,0,1] row_mask:0xf bank_mask:0xf
  s_nop 1
  v_add_f32_dpp v17, v17, v17 row_half_mirror row_mask:0xf bank_mask:0xf
  s_nop 1
  v_add_f32_dpp v17, v17, v17 row_mirror row_mask:0xf bank_mask:0xf
  v_mov_b32 v11, v17
  s_nop 1
  v_permlane16_swap_b32 v17, v11
  v_add_f32 v17, v17, v11
  v_mov_b32 v11, v17
  s_nop 1
  v_permlane32_swap_b32 v17, v11
  v_add_f32 v17, v17, v11
  v_rcp_f32 v17, v17
  v_and_b32 v12, 15, v1
  v_lshlrev_b32 v12, 4, v12
  v_lshl_add_u32 v12, v9, 2, v12
  v_add_u32 v12, v2, v12
  v_mul_f32 v16, v16, v17
  ds_write_b32 v12, v16 offset:5888
  s_mov_b64 exec, 1
  ds_add_u32 v2, v3 offset:5816
  s_mov_b64 exec, -1
XD_105:
  s_lshl_b32 s30, s38, 14
  s_lshl_b32 s32, s67, 6
  s_add_u32 s30, s30, s32
  v_and_b32 v13, 3, v1
  v_lshl_add_u32 v12, v13, 4, s30
  v_lshrrev_b32 v11, 2, v1
  v_lshl_add_u32 v12, v11, 8, v12
  v_lshlrev_b32 v13, 3, v13
  v_lshl_add_u32 v13, v9, 1, v13
  v_lshl_add_u32 v13, s67, 5, v13
  v_add_u32 v13, v2, v13
  v_lshl_add_u32 v14, v11, 4, v2
  v_lshrrev_b32 v11, 2, v1
  v_lshlrev_b32 v68, 9, v11
  v_and_b32 v74, 7, v11
  v_lshlrev_b32 v74, 1, v74
  v_lshrrev_b32 v75, 1, v1
  v_and_b32 v75, 1, v75
  v_lshl_add_u32 v75, s67, 3, v75
  v_xor_b32 v74, v74, v75
  v_lshl_add_u32 v68, v74, 4, v68
  v_and_b32 v74, 1, v1
  v_lshl_add_u32 v68, v74, 3, v68
  v_add_u32 v68, 98304, v68
  v_xor_b32 v69, 0x20, v68
  v_xor_b32 v70, 0x40, v68
  v_xor_b32 v71, 0x60, v68
  v_mov_b32 v202, 0
  v_mov_b32 v203, 0
  v_mov_b32 v204, 0
  v_mov_b32 v205, 0
  v_mov_b32 v206, 0
  v_mov_b32 v207, 0
  v_mov_b32 v208, 0
  v_mov_b32 v209, 0
  v_mov_b32 v210, 0
  v_mov_b32 v211, 0
  v_mov_b32 v212, 0
  v_mov_b32 v213, 0
  v_mov_b32 v214, 0
  v_mov_b32 v215, 0
  v_mov_b32 v216, 0
  v_mov_b32 v217, 0
  v_mov_b32 v218, 0
  v_mov_b32 v219, 0
  v_mov_b32 v220, 0
  v_mov_b32 v221, 0
  v_mov_b32 v222, 0
  v_mov_b32 v223, 0
  v_mov_b32 v224, 0
  v_mov_b32 v225, 0
  v_mov_b32 v226, 0
  v_mov_b32 v227, 0
  v_mov_b32 v228, 0
  v_mov_b32 v229, 0
  v_mov_b32 v230, 0
  v_mov_b32 v231, 0
  v_mov_b32 v232, 0
  v_mov_b32 v233, 0
  v_lshrrev_b32 v75, 4, v1
  v_lshl_add_u32 v72, v75, 3, v2
  v_add_u32 v72, 4864, v72
  v_lshlrev_b32 v73, 4, v75
  v_lshl_add_u32 v73, v74, 6, v73
  v_and_b32 v74, 2, v1
  v_lshl_add_u32 v73, v74, 12, v73
  s_lshr_b32 s45, s33, 1
  s_lshr_b32 s30, s2, 6
  s_lshl_b32 s30, s30, 4
  s_add_u32 s45, s45, s30
  s_lshl_b32 s45, s45, 7
  s_and_b32 s30, s33, 1
  s_lshl_b32 s30, s30, 17
  s_add_u32 s45, s45, s30
  s_lshl_b32 s30, s67, 14
  s_add_u32 s45, s45, s30
  s_add_u32 s45, s45, 524288
  s_mov_b32 s92, 0x100000
  s_mov_b32 s93, 0x101000
  s_mov_b32 s94, 0x102000
  s_mov_b32 s95, 0x103000
  s_mov_b32 s69, 524288
W_123:
  ds_read_b32 v11, v2 offset:5816
  s_waitcnt lgkmcnt(0)
  v_readfirstlane_b32 s30, v11
  s_nop 0
  s_cmp_ge_u32 s30, 1
  s_cbranch_scc1 WD_124
  s_sleep 1
  s_sub_u32 s69, s69, 1
  s_cbranch_scc0 W_123
WD_124:
  ds_read_b128 v[80:83], v14 offset:5888
  s_mov_b32 s69, 524288
W_125:
  ds_read_b32 v11, v2 offset:5836
  s_waitcnt lgkmcnt(0)
  v_readfirstlane_b32 s30, v11
  s_nop 0
  s_cmp_ge_u32 s30, 4
  s_cbranch_scc1 WD_126
  s_sleep 1
  s_sub_u32 s69, s69, 1
  s_cbranch_scc0 W_125
WD_126:
  buffer_load_dwordx4 v[100:103], v12, s[12:15], s92 offen sc1
  buffer_load_dwordx4 v[104:107], v12, s[12:15], s93 offen sc1
  buffer_load_dwordx4 v[108:111], v12, s[12:15], s94 offen sc1
  buffer_load_dwordx4 v[112:115], v12, s[12:15], s95 offen sc1
  s_mov_b32 s69, 524288
W_127:
  ds_read_b32 v11, v2 offset:5788
  s_waitcnt lgkmcnt(0)
  v_readfirstlane_b32 s30, v11
  s_nop 0
  s_cmp_ge_u32 s30, 4
  s_cbranch_scc1 WD_128
  s_sub_u32 s69, s69, 1
  s_cbranch_scc0 W_127
WD_128:
  ds_read_b64_tr_b16 v[120:121], v68 offset:0
  ds_read_b64_tr_b16 v[122:123], v68 offset:8192
  ds_read_b64_tr_b16 v[124:125], v68 offset:16384
  ds_read_b64_tr_b16 v[126:127], v68 offset:24576
  ds_read_b64_tr_b16 v[128:129], v69 offset:0
  ds_read_b64_tr_b16 v[130:131], v69 offset:8192
  ds_read_b64_tr_b16 v[132:133], v69 offset:16384
  ds_read_b64_tr_b16 v[134:135], v69 offset:24576
  ds_read_b64_tr_b16 v[136:137], v70 offset:0
  ds_read_b64_tr_b16 v[138:139], v70 offset:8192
  ds_read_b64_tr_b16 v[140:141], v70 offset:16384
  ds_read_b64_tr_b16 v[142:143], v70 offset:24576
  ds_read_b64_tr_b16 v[144:145], v71 offset:0
  ds_read_b64_tr_b16 v[146:147], v71 offset:8192
  ds_read_b64_tr_b16 v[148:149], v71 offset:16384
  ds_read_b64_tr_b16 v[150:151], v71 offset:24576
  s_mov_b32 s69, 524288
H_120:
  s_waitcnt vmcnt(0)
  v_perm_b32 v11, v103, v100, s89
  v_cmp_ne_u32 s[70:71], s87, v11
  v_perm_b32 v11, v107, v104, s89
  v_cmp_ne_u32 s[72:73], s87, v11
  v_perm_b32 v11, v111, v108, s89
  v_cmp_ne_u32 s[74:75], s87, v11
  v_perm_b32 v11, v115, v112, s89
  v_cmp_ne_u32 s[76:77], s87, v11
  s_bcnt1_i32_b64 s30, s[70:71]
  s_bcnt1_i32_b64 s31, s[72:73]
  s_add_u32 s30, s30, s31
  s_bcnt1_i32_b64 s31, s[74:75]
  s_add_u32 s30, s30, s31
  s_bcnt1_i32_b64 s31, s[76:77]
  s_add_u32 s30, s30, s31
  s_cmp_eq_u32 s30, 0
  s_cbranch_scc1 HD_121
  s_sub_u32 s69, s69, 1
  s_cbranch_scc1 HD_121
  s_cmp_le_u32 s30, 48
  s_cbranch_scc1 HS_122
  s_sleep 6
HS_122:
  s_wqm_b64 exec, s[70:71]
  s_cbranch_execz GS_129
  buffer_load_dwordx4 v[100:103], v12, s[12:15], s92 offen sc1
GS_129:
  s_wqm_b64 exec, s[72:73]
  s_cbranch_execz GS_130
  buffer_load_dwordx4 v[104:107], v12, s[12:15], s93 offen sc1
GS_130:
  s_wqm_b64 exec, s[74:75]
  s_cbranch_execz GS_131
  buffer_load_dwordx4 v[108:111], v12, s[12:15], s94 offen sc1
GS_131:
  s_wqm_b64 exec, s[76:77]
  s_cbranch_execz GS_132
  buffer_load_dwordx4 v[112:115], v12, s[12:15], s95 offen sc1
GS_132:
  s_mov_b64 exec, -1
  s_branch H_120
HD_121:
  v_and_b32 v100, v247, v100
  v_and_b32 v103, v247, v103
  v_and_b32 v104, v247, v104
  v_and_b32 v107, v247, v107
  v_and_b32 v108, v247, v108
  v_and_b32 v111, v247, v111
  v_and_b32 v112, v247, v112
  v_and_b32 v115, v247, v115
  v_pk_mul_f32 v[100:101], v[100:101], v[80:81] op_sel:[0,0] op_sel_hi:[1,0]
  v_pk_mul_f32 v[102:103], v[102:103], v[80:81] op_sel:[0,0] op_sel_hi:[1,0]
  v_pk_fma_f32 v[100:101], v[104:105], v[80:81], v[100:101] op_sel:[0,1,0] op_sel_hi:[1,1,1]
  v_pk_fma_f32 v[102:103], v[106:107], v[80:81], v[102:103] op_sel:[0,1,0] op_sel_hi:[1,1,1]
  v_pk_fma_f32 v[100:101], v[108:109], v[82:83], v[100:101] op_sel:[0,0,0] op_sel_hi:[1,0,1]
  v_pk_fma_f32 v[102:103], v[110:111], v[82:83], v[102:103] op_sel:[0,0,0] op_sel_hi:[1,0,1]
  v_pk_fma_f32 v[100:101], v[112:113], v[82:83], v[100:101] op_sel:[0,1,0] op_sel_hi:[1,1,1]
  v_pk_fma_f32 v[102:103], v[114:115], v[82:83], v[102:103] op_sel:[0,1,0] op_sel_hi:[1,1,1]
  s_nop 1
  v_permlane32_swap_b32 v100, v102
  v_permlane32_swap_b32 v101, v103
  v_pk_add_f32 v[100:101], v[100:101], v[102:103]
  s_nop 1
  v_permlane16_swap_b32 v100, v101
  v_add_f32 v100, v100, v101
  s_nop 1
  v_add_f32_dpp v100, v100, v100 row_ror:4 row_mask:0xf bank_mask:0xf
  s_nop 1
  v_add_f32_dpp v100, v100, v100 row_ror:8 row_mask:0xf bank_mask:0xf
  v_cvt_pk_bf16_f32 v100, 0, v100
  s_mov_b32 exec_lo, 0xf000f
  s_mov_b32 exec_hi, 0xf000f
  ds_write_b16_d16_hi v13, v100 offset:4864
  s_waitcnt lgkmcnt(0)
  s_barrier
  s_mov_b32 exec_lo, 0x10001
  s_mov_b32 exec_hi, 0x10001
  ds_read2_b64 v[202:205], v72 offset0:0 offset1:4
  ds_read2_b64 v[206:209], v72 offset0:8 offset1:12
  s_mov_b32 exec_lo, 0x20002
  s_mov_b32 exec_hi, 0x20002
  ds_read2_b64 v[210:213], v72 offset0:0 offset1:4
  ds_read2_b64 v[214:217], v72 offset0:8 offset1:12
  s_mov_b32 exec_lo, 0x40004
  s_mov_b32 exec_hi, 0x40004
  ds_read2_b64 v[218:221], v72 offset0:0 offset1:4
  ds_read2_b64 v[222:225], v72 offset0:8 offset1:12
  s_mov_b32 exec_lo, 0x80008
  s_mov_b32 exec_hi, 0x80008
  ds_read2_b64 v[226:229], v72 offset0:0 offset1:4
  ds_read2_b64 v[230:233], v72 offset0:8 offset1:12
  s_mov_b64 exec, -1
  s_waitcnt lgkmcnt(7)
  v_mfma_f32_16x16x32_bf16 v[24:27], v[120:123], v[202:205], 0
  s_waitcnt lgkmcnt(6)
  v_mfma_f32_16x16x32_bf16 v[24:27], v[124:127], v[206:209], v[24:27]
  s_waitcnt lgkmcnt(5)
  v_mfma_f32_16x16x32_bf16 v[24:27], v[128:131], v[210:213], v[24:27]
  s_waitcnt lgkmcnt(4)
  v_mfma_f32_16x16x32_bf16 v[24:27], v[132:135], v[214:217], v[24:27]
  s_waitcnt lgkmcnt(3)
  v_mfma_f32_16x16x32_bf16 v[24:27], v[136:139], v[218:221], v[24:27]
  s_waitcnt lgkmcnt(2)
  v_mfma_f32_16x16x32_bf16 v[24:27], v[140:143], v[222:225], v[24:27]
  s_waitcnt lgkmcnt(1)
  v_mfma_f32_16x16x32_bf16 v[24:27], v[144:147], v[226:229], v[24:27]
  s_waitcnt lgkmcnt(0)
  v_mfma_f32_16x16x32_bf16 v[24:27], v[148:151], v[230:233], v[24:27]
  s_mov_b32 exec_lo, 0xf000f
  s_mov_b32 exec_hi, 0xf000f
  s_nop 5
  v_and_or_b32 v24, v24, v247, s62
  v_and_or_b32 v27, v27, v247, s86
  buffer_store_dwordx4 v[24:27], v73, s[12:15], s45 offen sc1
  s_mov_b64 exec, -1
XM_106:
  s_cmp_lg_u32 s67, 2
  s_cbranch_scc1 L_fin2
  s_and_b32 s30, s2, 7
  s_cmp_lg_u32 s30, 0
  s_cbranch_scc1 L_fin2
  v_lshrrev_b32 v9, 4, v1
  v_and_b32 v13, 7, v1
  v_lshl_add_u32 v30, v13, 2, v9
  v_lshl_add_u32 v30, s91, 2, v30
  v_lshlrev_b32 v29, 1, v30
  v_lshlrev_b32 v30, 2, v30
  v_lshrrev_b32 v11, 3, v1
  v_and_b32 v11, 1, v11
  v_cmp_eq_u32 s[100:101], 1, v11
  v_lshl_add_u32 v28, v11, 15, v30
  v_lshlrev_b32 v31, 4, v11
  v_lshl_add_u32 v31, v9, 2, v31
  v_lshl_add_u32 v31, s91, 2, v31
  v_lshlrev_b32 v5, 4, v1
  v_lshl_add_u32 v6, v1, 4, v2
  v_add_u32 v150, 1, v1
  v_and_b32 v150, 3, v150
  v_xor_b32 v150, s86, v150
  v_mov_b32 v151, s66
  v_and_b32 v158, 3, v151
  v_cmp_eq_u32 vcc, 3, v9
  s_nop 1
  v_cndmask_b32 v158, v158, v151, vcc
  s_mov_b32 s69, 524288
W_133:
  ds_read_b32 v12, v2 offset:5868
  s_waitcnt lgkmcnt(0)
  v_readfirstlane_b32 s30, v12
  s_nop 0
  s_cmp_ge_u32 s30, 1
  s_cbranch_scc1 WD_134
  s_sleep 1
  s_sub_u32 s69, s69, 1
  s_cbranch_scc0 W_133
WD_134:
  s_cmp_eq_u32 s30, 1
  s_cselect_b32 s44, 0, 4096
  s_mov_b32 s69, 524288
W_135:
  ds_read_b32 v11, v2 offset:5852
  s_waitcnt lgkmcnt(0)
  v_readfirstlane_b32 s30, v11
  s_nop 0
  s_cmp_ge_u32 s30, 4
  s_cbranch_scc1 WD_136
  s_sleep 2
  s_sub_u32 s69, s69, 1
  s_cbranch_scc0 W_135
WD_136:
  v_mov_b32 v152, 0
  global_load_short_d16_hi v152, v29, s[36:37]
  v_lshlrev_b32 v12, 4, v1
  v_lshl_add_u32 v12, s91, 10, v12
  v_mov_b32 v46, 0x3a800000
  s_mov_b32 s40, 335872
  v_mov_b32 v150, 4095
  s_mov_b32 s59, 425984
  s_mov_b32 s92, 0x80000
  s_mov_b32 s93, 0x81000
  buffer_load_dwordx4 v[100:103], v12, s[12:15], s92 offen offset:0 sc1
  buffer_load_dwordx4 v[104:107], v12, s[12:15], s92 offen offset:1024 sc1
  buffer_load_dwordx4 v[108:111], v12, s[12:15], s92 offen offset:2048 sc1
  buffer_load_dwordx4 v[112:115], v12, s[12:15], s92 offen offset:3072 sc1
  buffer_load_dwordx4 v[116:119], v12, s[12:15], s93 offen offset:0 sc1
  buffer_load_dwordx4 v[120:123], v12, s[12:15], s93 offen offset:1024 sc1
  buffer_load_dwordx4 v[124:127], v12, s[12:15], s93 offen offset:2048 sc1
  buffer_load_dwordx4 v[128:131], v12, s[12:15], s93 offen offset:3072 sc1
  s_mov_b32 s69, 524288
  s_waitcnt vmcnt(0)
G_137:
  v_perm_b32 v11, v103, v100, s89
  v_cmp_ne_u32 s[70:71], s87, v11
  v_perm_b32 v11, v107, v104, s89
  v_cmp_ne_u32 s[72:73], s87, v11
  v_perm_b32 v11, v111, v108, s89
  v_cmp_ne_u32 s[74:75], s87, v11
  v_perm_b32 v11, v115, v112, s89
  v_cmp_ne_u32 s[76:77], s87, v11
  v_perm_b32 v11, v119, v116, s89
  v_cmp_ne_u32 s[78:79], s87, v11
  v_perm_b32 v11, v123, v120, s89
  v_cmp_ne_u32 s[80:81], s87, v11
  v_perm_b32 v11, v127, v124, s89
  v_cmp_ne_u32 s[82:83], s87, v11
  v_perm_b32 v11, v131, v128, s89
  v_cmp_ne_u32 s[84:85], s87, v11
  s_or_b64 s[28:29], s[70:71], s[72:73]
  s_or_b64 s[28:29], s[28:29], s[74:75]
  s_or_b64 s[28:29], s[28:29], s[76:77]
  s_or_b64 s[28:29], s[28:29], s[78:79]
  s_or_b64 s[28:29], s[28:29], s[80:81]
  s_or_b64 s[28:29], s[28:29], s[82:83]
  s_or_b64 s[28:29], s[28:29], s[84:85]
  s_cbranch_scc0 GD_138
  s_sub_u32 s69, s69, 1
  s_cbranch_scc1 GD_138
  s_or_b32 s70, s70, 1
  s_wqm_b64 exec, s[70:71]
  buffer_load_dwordx4 v[100:103], v12, s[12:15], s92 offen offset:0 sc1
  s_or_b32 s72, s72, 1
  s_wqm_b64 exec, s[72:73]
  buffer_load_dwordx4 v[104:107], v12, s[12:15], s92 offen offset:1024 sc1
  s_or_b32 s74, s74, 1
  s_wqm_b64 exec, s[74:75]
  buffer_load_dwordx4 v[108:111], v12, s[12:15], s92 offen offset:2048 sc1
  s_or_b32 s76, s76, 1
  s_wqm_b64 exec, s[76:77]
  buffer_load_dwordx4 v[112:115], v12, s[12:15], s92 offen offset:3072 sc1
  s_or_b32 s78, s78, 1
  s_wqm_b64 exec, s[78:79]
  buffer_load_dwordx4 v[116:119], v12, s[12:15], s93 offen offset:0 sc1
  s_or_b32 s80, s80, 1
  s_wqm_b64 exec, s[80:81]
  buffer_load_dwordx4 v[120:123], v12, s[12:15], s93 offen offset:1024 sc1
  s_or_b32 s82, s82, 1
  s_wqm_b64 exec, s[82:83]
  buffer_load_dwordx4 v[124:127], v12, s[12:15], s93 offen offset:2048 sc1
  s_or_b32 s84, s84, 1
  s_wqm_b64 exec, s[84:85]
  buffer_load_dwordx4 v[128:131], v12, s[12:15], s93 offen offset:3072 sc1
  s_mov_b64 exec, -1
  s_sleep 2
  s_waitcnt vmcnt(8)
  s_branch G_137
GD_138:
  s_waitcnt vmcnt(0)
  ds_read_b32 v11, v2 offset:5840
  ds_read_b128 v[140:143], v6 offset:6656
  v_and_b32 v100, v247, v100
  v_and_b32 v103, v247, v103
  v_and_b32 v104, v247, v104
  v_and_b32 v107, v247, v107
  v_and_b32 v108, v247, v108
  v_and_b32 v111, v247, v111
  v_and_b32 v112, v247, v112
  v_and_b32 v115, v247, v115
  v_and_b32 v116, v247, v116
  v_and_b32 v119, v247, v119
  v_and_b32 v120, v247, v120
  v_and_b32 v123, v247, v123
  v_and_b32 v124, v247, v124
  v_and_b32 v127, v247, v127
  v_and_b32 v128, v247, v128
  v_and_b32 v131, v247, v131
  v_pk_add_f32 v[100:101], v[100:101], v[104:105]
  v_pk_add_f32 v[102:103], v[102:103], v[106:107]
  v_pk_add_f32 v[108:109], v[108:109], v[112:113]
  v_pk_add_f32 v[110:111], v[110:111], v[114:115]
  v_pk_add_f32 v[116:117], v[116:117], v[120:121]
  v_pk_add_f32 v[118:119], v[118:119], v[122:123]
  v_pk_add_f32 v[124:125], v[124:125], v[128:129]
  v_pk_add_f32 v[126:127], v[126:127], v[130:131]
  v_pk_add_f32 v[100:101], v[100:101], v[108:109]
  v_pk_add_f32 v[102:103], v[102:103], v[110:111]
  v_pk_add_f32 v[116:117], v[116:117], v[124:125]
  v_pk_add_f32 v[118:119], v[118:119], v[126:127]
  v_pk_add_f32 v[100:101], v[100:101], v[116:117]
  v_pk_add_f32 v[102:103], v[102:103], v[118:119]
  s_nop 1
  v_permlane32_swap_b32 v100, v102
  v_permlane32_swap_b32 v101, v103
  v_pk_add_f32 v[100:101], v[100:101], v[102:103]
  s_nop 1
  v_permlane16_swap_b32 v100, v101
  v_add_f32 v100, v100, v101
  s_nop 1
  v_add_f32_dpp v100, v100, v100 row_ror:8 row_mask:0xf bank_mask:0xf
  v_cvt_pk_bf16_f32 v100, 0, v100
  s_waitcnt lgkmcnt(0)
  v_readfirstlane_b32 s30, v11
  s_nop 0
  s_cmp_ge_u32 s30, 1
  s_cbranch_scc1 LA_139
  s_mov_b32 s69, 524288
W_140:
  ds_read_b32 v11, v2 offset:5840
  s_waitcnt lgkmcnt(0)
  v_readfirstlane_b32 s30, v11
  s_nop 0
  s_cmp_ge_u32 s30, 1
  s_cbranch_scc1 WD_141
  s_sub_u32 s69, s69, 1
  s_cbranch_scc0 W_140
WD_141:
  ds_read_b128 v[140:143], v6 offset:6656
  s_waitcnt lgkmcnt(0)
LA_139:
  v_mul_f32 v16, v100, v140
  v_cndmask_b32 v157, v142, v141, s[100:101]
  v_mov_b32 v23, 0
  v_cvt_pk_bf16_f32 v16, 0, v16
  v_add_f32 v16, v16, v152
  v_cvt_pk_bf16_f32 v16, 0, v16
  v_mul_f32 v17, v16, v142
  v_cndmask_b32 v18, v16, v17, s[100:101]
  v_cndmask_b32 v20, 1.0, v17, s[100:101]
  v_cndmask_b32 v21, v16, v142, s[100:101]
  v_mul_f32 v20, v18, v20
  v_mul_f32 v21, v18, v21
  v_mul_f32 v22, v18, v157
  s_nop 1
  v_permlane32_swap_b32 v20, v22
  v_permlane32_swap_b32 v21, v23
  v_pk_add_f32 v[20:21], v[20:21], v[22:23]
  s_nop 1
  v_permlane16_swap_b32 v20, v21
  v_add_f32 v20, v20, v21
  s_nop 1
  v_add_f32_dpp v20, v20, v20 quad_perm:[1,0,3,2] row_mask:0xf bank_mask:0xf
  s_nop 1
  v_add_f32_dpp v20, v20, v20 quad_perm:[2,3,0,1] row_mask:0xf bank_mask:0xf
  s_nop 1
  v_add_f32_dpp v20, v20, v20 row_half_mirror row_mask:0xf bank_mask:0xf
  v_and_or_b32 v20, v20, -4, v158
  s_mov_b32 exec_lo, 0x1010101
  s_mov_b32 exec_hi, 0x1010101
  s_cmp_lg_u32 s44, 0
  s_cbranch_scc1 SB_142
  buffer_store_dword v20, v31, s[12:15], s40 offen
SE_143:
  s_mov_b64 exec, -1
  s_add_u32 s92, s44, 0x52000
  buffer_load_dwordx4 v[100:103], v5, s[12:15], s92 offen sc1
  s_mov_b32 s69, 524288
G_144:
  s_waitcnt vmcnt(0)
  v_bitop3_b32 v26, v100, v101, v103 bitop3:0x7e
  v_xor_b32 v27, v102, v103
  v_xor_b32 v25, s66, v103
  v_or_b32 v26, v26, v27
  v_and_or_b32 v26, v26, 3, v25
  v_cmp_ne_u32 vcc, 0, v26
  s_cbranch_vccz GD_145
  s_mov_b64 exec, vcc
  buffer_load_dwordx4 v[100:103], v5, s[12:15], s92 offen sc1
  s_mov_b64 exec, -1
  s_sub_u32 s69, s69, 1
  s_cbranch_scc0 G_144
  s_waitcnt vmcnt(0)
GD_145:
  ds_read_b32 v11, v2 offset:5828
  ds_read_b128 v[144:147], v2 offset:7680
  ds_read_b64 v[148:149], v2 offset:7696
  v_and_b32 v100, -4, v100
  v_and_b32 v101, -4, v101
  v_and_b32 v102, -4, v102
  s_nop 1
  v_permlane32_swap_b32 v100, v102
  v_permlane32_swap_b32 v101, v103
  v_pk_add_f32 v[100:101], v[100:101], v[102:103]
  s_nop 1
  v_permlane16_swap_b32 v100, v101
  v_add_f32 v100, v100, v101
  s_nop 1
  v_add_f32_dpp v100, v100, v100 quad_perm:[2,3,0,1] row_mask:0xf bank_mask:0xf
  s_nop 1
  v_add_f32_dpp v100, v100, v100 row_ror:4 row_mask:0xf bank_mask:0xf
  s_nop 1
  v_add_f32_dpp v100, v100, v100 row_ror:8 row_mask:0xf bank_mask:0xf
  s_nop 0
  v_readlane_b32 s38, v100, 0
  v_readlane_b32 s39, v100, 16
  v_readlane_b32 s40, v100, 32
  v_readlane_b32 s41, v100, 1
  v_readlane_b32 s42, v100, 17
  v_readlane_b32 s43, v100, 33
  v_mul_f32 v24, s38, v46
  v_mul_f32 v25, s39, v46
  v_fma_f32 v25, -v24, v24, v25
  v_max_f32 v25, 0, v25
  v_cvt_pk_bf16_f32 v25, 0, v25
  v_cvt_pk_bf16_f32 v24, 0, v24
  v_add_f32 v25, 0x3727c5ac, v25
  v_cvt_pk_bf16_f32 v25, 0, v25
  v_sqrt_f32 v25, v25
  s_nop 0
  v_cvt_pk_bf16_f32 v25, 0, v25
  v_rcp_f32 v25, v25
  s_waitcnt lgkmcnt(0)
  v_readfirstlane_b32 s30, v11
  s_nop 0
  s_cmp_ge_u32 s30, 1
  s_cbranch_scc1 LA_146
  s_mov_b32 s69, 524288
W_147:
  ds_read_b32 v11, v2 offset:5828
  s_waitcnt lgkmcnt(0)
  v_readfirstlane_b32 s30, v11
  s_nop 0
  s_cmp_ge_u32 s30, 1
  s_cbranch_scc1 WD_148
  s_sub_u32 s69, s69, 1
  s_cbranch_scc0 W_147
WD_148:
  ds_read_b128 v[144:147], v2 offset:7680
  ds_read_b64 v[148:149], v2 offset:7696
  s_waitcnt lgkmcnt(0)
LA_146:
  v_fma_f32 v26, -v24, v144, s40
  v_fma_f32 v28, -v24, v149, s43
  v_mul_f32 v27, v24, v145
  v_fma_f32 v27, -2.0, s42, v27
  v_fma_f32 v27, v27, v24, s41
  v_sub_f32 v40, v16, v24
  v_fma_f32 v26, v26, v25, v146
  v_add_f32 v28, v28, v28
  v_fma_f32 v27, v27, v25, v28
  v_fma_f32 v27, v27, v25, v148
  v_cvt_pk_bf16_f32 v40, 0, v40
  v_mul_f32 v26, v26, v46
  v_mul_f32 v27, v27, v46
  v_mul_f32 v40, v40, v25
  v_fma_f32 v27, -v26, v26, v27
  v_cvt_pk_bf16_f32 v40, 0, v40
  v_max_f32 v27, 0, v27
  v_mul_f32 v40, v40, v142
  v_cvt_pk_bf16_f32 v27, 0, v27
  v_cvt_pk_bf16_f32 v40, 0, v40
  v_cvt_pk_bf16_f32 v26, 0, v26
  v_add_f32 v27, 0x3727c5ac, v27
  v_add_f32 v40, v40, v141
  v_cvt_pk_bf16_f32 v27, 0, v27
  v_cvt_pk_bf16_f32 v40, 0, v40
  v_sqrt_f32 v27, v27
  v_sub_f32 v40, v40, v26
  v_cvt_pk_bf16_f32 v27, 0, v27
  v_cvt_pk_bf16_f32 v40, 0, v40
  v_rcp_f32 v27, v27
  s_nop 0
  v_mul_f32 v40, v40, v27
  v_cvt_pk_bf16_f32 v40, 0, v40
  v_bfe_u32 v41, v40, 16, 15
  v_lshrrev_b32 v43, 31, v40
  v_subrev_u32 v42, 12928, v41
  v_cmp_eq_u32 vcc, 0, v41
  v_cmp_lt_u32 s[38:39], v42, v150
  v_lshl_add_u32 v42, v43, 12, v42
  v_cndmask_b32 v42, v42, v150, vcc
  v_and_b32 v42, 0x1fff, v42
  v_lshlrev_b32 v42, 2, v42
  buffer_load_dword v41, v42, s[12:15], s59 offen sc1
  ds_read_b32 v11, v2 offset:5864
  ds_read_b32 v143, v6 offset:7808
  s_or_b64 s[38:39], s[38:39], vcc
  s_waitcnt lgkmcnt(0)
  v_readfirstlane_b32 s30, v11
  s_nop 0
  s_cmp_ge_u32 s30, 1
  s_cbranch_scc1 LA_149
  s_mov_b32 s69, 524288
W_150:
  ds_read_b32 v11, v2 offset:5864
  s_waitcnt lgkmcnt(0)
  v_readfirstlane_b32 s30, v11
  s_nop 0
  s_cmp_ge_u32 s30, 1
  s_cbranch_scc1 WD_151
  s_sub_u32 s69, s69, 1
  s_cbranch_scc0 W_150
WD_151:
  ds_read_b32 v143, v6 offset:7808
  s_waitcnt lgkmcnt(0)
LA_149:
  s_waitcnt vmcnt(0)
  v_and_b32 v42, 0xffff, v41
  v_and_b32 v41, 0xffff0000, v41
  v_cmp_ne_u32 vcc, s86, v42
  s_nop 0
  s_orn2_b64 s[38:39], vcc, s[38:39]
  s_cbranch_scc1 L_slow1
L_out:
  v_mul_f32 v41, v41, v143
  v_cvt_pk_bf16_f32 v41, 0, v41
  v_add_f32 v41, v41, v16
  v_cvt_pk_bf16_f32 v41, 0, v41
  s_mov_b32 exec_lo, 0xff00ff
  s_mov_b32 exec_hi, 0xff00ff
  global_store_short_d16_hi v29, v41, s[60:61]
  s_mov_b64 exec, -1
L_fin:
  s_cmp_lg_u32 s2, 0
  s_cbranch_scc1 L_fin2
  v_mov_b32 v7, s66
  v_mov_b32 v8, 0
  s_mov_b64 exec, 1
  global_store_dword v8, v7, s[64:65] offset:12
  s_mov_b64 exec, -1
L_fin2:
L_end:
  s_endpgm
L_slow1:
  s_ff1_i32_b64 s40, s[38:39]
  s_bitset0_b64 s[38:39], s40
  v_readlane_b32 s41, v40, s40
  v_lshlrev_b32 v11, 4, v1
  v_mov_b32 v18, 0
  v_mov_b32 v19, 0
  v_mov_b32 v42, s41
  v_mov_b32 v43, s41
  s_mov_b32 s42, 0
L_slow2:
  global_load_dwordx4 v[100:103], v11, s[48:49]
  global_load_dwordx4 v[104:107], v11, s[50:51]
  global_load_dwordx4 v[108:111], v11, s[52:53]
  v_add_u32 v11, 0x400, v11
  s_waitcnt vmcnt(0)
  v_lshlrev_b32 v160, 16, v100
  v_and_b32 v161, 0xffff0000, v100
  v_lshlrev_b32 v162, 16, v101
  v_and_b32 v163, 0xffff0000, v101
  v_lshlrev_b32 v164, 16, v102
  v_and_b32 v165, 0xffff0000, v102
  v_lshlrev_b32 v166, 16, v103
  v_and_b32 v167, 0xffff0000, v103
  v_lshlrev_b32 v168, 16, v104
  v_and_b32 v169, 0xffff0000, v104
  v_lshlrev_b32 v170, 16, v105
  v_and_b32 v171, 0xffff0000, v105
  v_lshlrev_b32 v172, 16, v106
  v_and_b32 v173, 0xffff0000, v106
  v_lshlrev_b32 v174, 16, v107
  v_and_b32 v175, 0xffff0000, v107
  v_lshlrev_b32 v176, 16, v108
  v_and_b32 v177, 0xffff0000, v108
  v_lshlrev_b32 v178, 16, v109
  v_and_b32 v179, 0xffff0000, v109
  v_lshlrev_b32 v180, 16, v110
  v_and_b32 v181, 0xffff0000, v110
  v_lshlrev_b32 v182, 16, v111
  v_and_b32 v183, 0xffff0000, v111
  v_pk_fma_f32 v[48:49], v[42:43], v[160:161], v[168:169]
  v_pk_fma_f32 v[50:51], v[42:43], v[162:163], v[170:171]
  v_pk_fma_f32 v[52:53], v[42:43], v[164:165], v[172:173]
  v_pk_fma_f32 v[54:55], v[42:43], v[166:167], v[174:175]
  v_pk_mul_f32 v[64:65], v[48:49], v[48:49]
  v_pk_mul_f32 v[66:67], v[50:51], v[50:51]
  v_pk_mul_f32 v[68:69], v[52:53], v[52:53]
  v_pk_mul_f32 v[70:71], v[54:55], v[54:55]
  v_pk_fma_f32 v[64:65], v[64:65], v[44:45], v[44:45] op_sel:[0,0,1] op_sel_hi:[1,0,1]
  v_pk_fma_f32 v[66:67], v[66:67], v[44:45], v[44:45] op_sel:[0,0,1] op_sel_hi:[1,0,1]
  v_pk_fma_f32 v[68:69], v[68:69], v[44:45], v[44:45] op_sel:[0,0,1] op_sel_hi:[1,0,1]
  v_pk_fma_f32 v[70:71], v[70:71], v[44:45], v[44:45] op_sel:[0,0,1] op_sel_hi:[1,0,1]
  v_pk_mul_f32 v[64:65], v[64:65], v[48:49]
  v_pk_mul_f32 v[66:67], v[66:67], v[50:51]
  v_pk_mul_f32 v[68:69], v[68:69], v[52:53]
  v_pk_mul_f32 v[70:71], v[70:71], v[54:55]
  v_exp_f32 v64, v64
  v_exp_f32 v65, v65
  v_exp_f32 v66, v66
  v_exp_f32 v67, v67
  v_exp_f32 v68, v68
  v_exp_f32 v69, v69
  v_exp_f32 v70, v70
  v_exp_f32 v71, v71
  v_pk_add_f32 v[64:65], v[64:65], 1.0 op_sel_hi:[1,0]
  v_pk_add_f32 v[66:67], v[66:67], 1.0 op_sel_hi:[1,0]
  v_pk_add_f32 v[68:69], v[68:69], 1.0 op_sel_hi:[1,0]
  v_pk_add_f32 v[70:71], v[70:71], 1.0 op_sel_hi:[1,0]
  v_rcp_f32 v64, v64
  v_rcp_f32 v65, v65
  v_rcp_f32 v66, v66
  v_rcp_f32 v67, v67
  v_rcp_f32 v68, v68
  v_rcp_f32 v69, v69
  v_rcp_f32 v70, v70
  v_rcp_f32 v71, v71
  v_pk_mul_f32 v[48:49], v[48:49], v[64:65]
  v_pk_mul_f32 v[50:51], v[50:51], v[66:67]
  v_pk_mul_f32 v[52:53], v[52:53], v[68:69]
  v_pk_mul_f32 v[54:55], v[54:55], v[70:71]
  v_pk_fma_f32 v[18:19], v[48:49], v[176:177], v[18:19]
  v_pk_fma_f32 v[18:19], v[50:51], v[178:179], v[18:19]
  v_pk_fma_f32 v[18:19], v[52:53], v[180:181], v[18:19]
  v_pk_fma_f32 v[18:19], v[54:55], v[182:183], v[18:19]
  s_add_u32 s42, s42, 1
  s_cmp_lt_u32 s42, 7
  s_cbranch_scc1 L_slow2
  v_add_f32 v18, v18, v19
  s_nop 1
  v_add_f32_dpp v18, v18, v18 quad_perm:[1,0,3,2] row_mask:0xf bank_mask:0xf
  s_nop 1
  v_add_f32_dpp v18, v18, v18 quad_perm:[2,3,0,1] row_mask:0xf bank_mask:0xf
  s_nop 1
  v_add_f32_dpp v18, v18, v18 row_half_mirror row_mask:0xf bank_mask:0xf
  s_nop 1
  v_add_f32_dpp v18, v18, v18 row_mirror row_mask:0xf bank_mask:0xf
  v_mov_b32 v19, v18
  s_nop 1
  v_permlane16_swap_b32 v18, v19
  v_add_f32 v18, v18, v19
  v_mov_b32 v19, v18
  s_nop 1
  v_permlane32_swap_b32 v18, v19
  v_add_f32 v18, v18, v19
  v_cvt_pk_bf16_f32 v18, 0, v18
  v_add_f32 v18, v18, v159
  v_cvt_pk_bf16_f32 v18, 0, v18
  s_nop 0
  v_readfirstlane_b32 s41, v18
  s_mov_b32 m0, s40
  s_nop 0
  v_writelane_b32 v41, s41, m0
  s_cmp_lg_u64 s[38:39], 0
  s_cbranch_scc1 L_slow1
  s_branch L_out
SB_70:
  s_add_u32 s41, s41, s44
  buffer_store_dword v20, v31, s[12:15], s41 offen sc1
  s_branch SE_71
SB_142:
  s_add_u32 s40, s40, s44
  buffer_store_dword v20, v31, s[12:15], s40 offen sc1
  s_branch SE_143
L_code_end:
.section .rodata,"a"
.p2align 6
.amdhsa_kernel adaLN_cond__gqa_block_cached__mixer_token_mlp__decode_kernel
  .amdhsa_next_free_vgpr 256
  .amdhsa_next_free_sgpr 102
  .amdhsa_accum_offset 256
  .amdhsa_group_segment_fixed_size 0
  .amdhsa_kernarg_size 120
  .amdhsa_user_sgpr_count 2
  .amdhsa_user_sgpr_kernarg_segment_ptr 1
  .amdhsa_system_sgpr_workgroup_id_x 1
  .amdhsa_float_denorm_mode_32 3
.end_amdhsa_kernel
```
